```python
import torch

def _softmax(x, axis=-1):
    return torch.softmax(x, dim=axis)
def _gelu(x):
    return torch.nn.functional.gelu(x, approximate="tanh")
def _silu(x):
    return torch.nn.functional.silu(x)
def _sigmoid(x):
    return torch.sigmoid(x)
def _layernorm(x, axis=-1, eps=1e-5):
    m = x.mean(dim=axis, keepdim=True)
    v = x.var(dim=axis, keepdim=True, unbiased=False)
    return (x - m) / torch.sqrt(v + eps)
def _scatter_add(tgt, idx, src, axis=0):
    return tgt.clone().index_add_(axis, idx, src)
def _segment_sum(src, seg, n):
    out = torch.zeros((n,) + src.shape[1:], dtype=src.dtype)
    return out.index_add_(0, seg, src)
def _pad(x, pw):
    flat = tuple(v for pair in reversed(pw) for v in pair)
    return torch.nn.functional.pad(x, flat)

kernel_name = 'sequential_preLN__ssm_conv_h3__dense_activation_silu__prompt'

def setup_inputs():

    _w = (lambda a: (lambda t: t.to(torch.bfloat16) if t.is_floating_point() else t)(torch.as_tensor(a)))
    def _A_setup():
        B, S, D = 1, 2048, 1024
        ks = 4
        return {
            "q": _w((lambda *s: torch.randn(*s, dtype=torch.bfloat16) * 0.05)(B, S, D)),
            "k": _w((lambda *s: torch.randn(*s, dtype=torch.bfloat16) * 0.2)(B, S, D)),
            "v": _w((lambda *s: torch.randn(*s, dtype=torch.bfloat16) * 0.2)(B, S, D)),
            "shift_k": _w((lambda *s: torch.randn(*s, dtype=torch.bfloat16) * 0.2)(D, ks) * 0.5),
            "ssm_k": _w((lambda *s: torch.randn(*s, dtype=torch.bfloat16) * 0.4)(D, S) * (1.0 / S ** 0.5)),
            "ssm_D": _w((lambda *s: torch.randn(*s, dtype=torch.bfloat16) * 0.2)(D)),
        }
    _A_in = _A_setup()

    def _B_setup():
        B, S, D, F = 1, 2048, 1024, 3584
        return {
            "x": _w((lambda *s: torch.randn(*s, dtype=torch.bfloat16) * 0.05)(B, S, D)),
            "w1": _w((lambda *s: torch.randn(*s, dtype=torch.bfloat16) * 0.8)(D, F) * (D ** -0.5)),
            "w2": _w((lambda *s: torch.randn(*s, dtype=torch.bfloat16) * 0.1)(F, D) * (F ** -0.5)),
        }
    _B_in = _B_setup()

    return {
        "A_q": _A_in["q"],
        "A_k": _A_in["k"],
        "A_v": _A_in["v"],
        "A_shift_k": _A_in["shift_k"],
        "A_ssm_k": _A_in["ssm_k"],
        "A_ssm_D": _A_in["ssm_D"],
        "B_x": _B_in["x"],
        "B_w1": _B_in["w1"],
        "B_w2": _B_in["w2"],
    }

def reference(A_q, A_k, A_v, A_shift_k, A_ssm_k, A_ssm_D, B_x, B_w1, B_w2):
    def _A_ref(q, k, v, shift_k, ssm_k, ssm_D):
        B, S, D = q.shape
        ks = shift_k.shape[-1]
        k_pad = _pad(k, ((0, 0), (ks - 1, 0), (0, 0)))
        k_shift = torch.zeros_like(k)
        for t in range(ks):
            k_shift = k_shift + k_pad[:, t:t + S, :] * shift_k[:, ks - 1 - t][None, None, :]
        kv = k_shift * v
        L = 2 * S
        kv_pad = _pad(kv, ((0, 0), (0, S), (0, 0)))
        kf_pad = _pad(ssm_k, ((0, 0), (0, S)))
        kv_f = (lambda x, axes=(-2,-1): torch.fft.rfft2(x.float(), dim=axes))(kv_pad[:, None, :, :], axes=(1, 2))
        kf_f = (lambda x, axes=(-2,-1): torch.fft.rfft2(x.float(), dim=axes))(kf_pad[:, None, :], axes=(1, 2))
        kf_f = (lambda x, *d: x.permute(*d))(kf_f, 1, 2, 0)
        y_f = kv_f * kf_f[None, :, :, :]
        y = (lambda x, s, axes=(-2,-1): torch.fft.irfft2(x, s=s, dim=axes).to(torch.bfloat16))(y_f, (1, L), axes=(1, 2))[:, 0, :S, :]
        y = y + kv * ssm_D[None, None, :]
        return q * y

    def _B_ref(x, w1, w2):
        h = torch.einsum("bsd,df->bsf", x, w1)
        h = _silu(h)
        out = torch.einsum("bsf,fd->bsd", h, w2)
        return out

    x = A_q
    h = x + _A_ref(_layernorm(x, axis=-1), A_k, A_v, A_shift_k, A_ssm_k, A_ssm_D)
    h2 = h + _B_ref(_layernorm(h, axis=-1), B_w1, B_w2)
    return h2
```

```asm
; @launch grid=(256,1,1) block=(512,1,1) lds=153792
.amdgcn_target "amdgcn-amd-amdhsa--gfx950"
.text
.globl sequential_preLN__ssm_conv_h3__dense_activation_silu__prompt_kernel
.p2align 8
.type sequential_preLN__ssm_conv_h3__dense_activation_silu__prompt_kernel,@function
sequential_preLN__ssm_conv_h3__dense_activation_silu__prompt_kernel:
    s_cmp_ge_u32 s2, 256
    s_cbranch_scc1 Lsequen_f_end
    s_load_dwordx8 s[4:11], s[0:1], 0
    s_load_dwordx4 s[52:55], s[0:1], 80
    s_load_dwordx4 s[12:15], s[0:1], 32
    s_load_dwordx4 s[56:59], s[0:1], 56
    v_lshrrev_b32 v1, 6, v0
    s_lshr_b32 s40, s2, 3
    v_readfirstlane_b32 s60, v1
    s_and_b32 s41, s2, 7
    s_lshl_b32 s61, s41, 7
    s_lshl_b32 s62, s40, 2
    s_add_u32 s61, s61, s62
    s_and_b32 s62, s60, 3
    s_add_u32 s61, s61, s62
    s_mul_i32 s63, s62, 21248
    s_add_u32 s63, s63, 0
    s_lshl_b32 s39, s41, 11
    v_mov_b32 v207, 0
    s_getreg_b32 s38, hwreg(HW_REG_XCC_ID, 0, 4)
    v_mov_b32 v206, s38
    s_cmp_ge_u32 s60, 4
    s_cbranch_scc1 Lsequen_f_bwave
    v_and_b32 v6, 15, v0
    v_lshrrev_b32 v7, 4, v0
    s_lshl_b32 s42, s40, 17
    s_lshl_b32 s43, s41, 8
    s_add_u32 s42, s42, s43
    v_lshlrev_b32 v1, 13, v7
    v_lshl_add_u32 v1, v6, 4, v1
    v_add_u32 v1, s42, v1
    v_add_u32 v2, 0x1000, v1
    v_add_u32 v3, 0xffffe800, v1
    v_add_u32 v4, 0xfffff000, v1
    v_add_u32 v5, 0xfffff800, v1
    s_lshl_b32 s48, s41, 10
    v_and_b32 v9, 63, v0
    v_lshlrev_b32 v9, 4, v9
    s_mov_b32 m0, 84992
    s_waitcnt lgkmcnt(0)
    s_mov_b32 s20, s6
    s_and_b32 s21, s7, 0xffff
    s_mov_b32 s22, 0x400000
    s_mov_b32 s23, 0x20000
    s_mov_b32 s24, s8
    s_and_b32 s25, s9, 0xffff
    s_mov_b32 s26, 0x400000
    s_mov_b32 s27, 0x20000
    s_mov_b32 s28, s10
    s_and_b32 s29, s11, 0xffff
    s_mov_b32 s30, 0x2000
    s_mov_b32 s31, 0x20000
    buffer_load_dwordx4 v9, s[28:31], s48 offen lds
    buffer_load_dwordx4 v[24:27], v1, s[20:23], 0 offen offset:0 nt
    buffer_load_dwordx4 v[28:31], v1, s[20:23], 0 offen offset:2048 nt
    buffer_load_dwordx4 v[32:35], v2, s[20:23], 0 offen offset:0 nt
    buffer_load_dwordx4 v[36:39], v2, s[20:23], 0 offen offset:2048 nt
    buffer_load_dwordx4 v[40:43], v1, s[24:27], 0 offen offset:0 nt
    buffer_load_dwordx4 v[44:47], v1, s[24:27], 0 offen offset:2048 nt
    buffer_load_dwordx4 v[48:51], v2, s[24:27], 0 offen offset:0 nt
    buffer_load_dwordx4 v[52:55], v2, s[24:27], 0 offen offset:2048 nt
    buffer_load_dwordx4 v[12:15], v3, s[20:23], 0 offen nt
    buffer_load_dwordx4 v[16:19], v4, s[20:23], 0 offen nt
    buffer_load_dwordx4 v[20:23], v5, s[20:23], 0 offen nt
    s_mov_b32 s16, s4
    s_and_b32 s17, s5, 0xffff
    s_mov_b32 s18, 0x400000
    s_mov_b32 s19, 0x20000
    buffer_load_dwordx4 v[56:59], v1, s[16:19], 0 offen offset:0 nt
    buffer_load_dwordx4 v[60:63], v1, s[16:19], 0 offen offset:2048 nt
    buffer_load_dwordx4 v[64:67], v2, s[16:19], 0 offen offset:0 nt
    buffer_load_dwordx4 v[68:71], v2, s[16:19], 0 offen offset:2048 nt
    s_mov_b32 s44, s52
    s_and_b32 s45, s53, 0xffff
    s_mov_b32 s46, 0x100
    s_mov_b32 s47, 0x20000
    buffer_load_dwordx2 v[204:205], v207, s[44:47], 0 offen sc1
    s_barrier
    s_mov_b32 s32, s54
    s_and_b32 s33, s55, 0xffff
    s_mov_b32 s34, 0x10000000
    s_mov_b32 s35, 0x20000
    s_and_b32 s3, s61, -2
    s_lshl_b32 s3, s3, 1
    s_load_dword s51, s[14:15], s3
    v_and_b32 v10, 14, v6
    v_xor_b32 v11, v10, v7
    v_xor_b32 v10, 1, v11
    v_lshlrev_b32 v8, 10, v6
    v_lshl_add_u32 v10, v10, 3, v8
    v_lshl_add_u32 v11, v11, 3, v8
    v_add_u32 v10, 90112, v10
    v_add_u32 v11, 90112, v11
    v_lshlrev_b32 v8, 6, v6
    v_add_u32 v8, 84992, v8
    s_mov_b32 s48, 0x05040100
    s_mov_b32 s49, 0x07060302
    s_mov_b32 s50, 0xffff0000
    s_waitcnt vmcnt(16)
    ds_read_b128 v[72:75], v8 offset:0
    ds_read_b128 v[76:79], v8 offset:16
    ds_read_b128 v[80:83], v8 offset:32
    ds_read_b128 v[84:87], v8 offset:48
    s_waitcnt vmcnt(5) lgkmcnt(0)
    v_mov_b32 v200, 153688
    v_mov_b32 v201, 1
    ds_write_b32 v200, v201
Lsequen_f_kv:
    v_lshlrev_b32 v104, 16, v72
    v_and_b32 v106, s50, v72
    v_lshlrev_b32 v108, 16, v73
    v_and_b32 v110, s50, v73
    v_lshlrev_b32 v105, 16, v74
    v_and_b32 v107, s50, v74
    v_lshlrev_b32 v109, 16, v75
    v_and_b32 v111, s50, v75
    v_lshlrev_b32 v112, 16, v12
    v_and_b32 v113, s50, v12
    v_lshlrev_b32 v114, 16, v16
    v_and_b32 v115, s50, v16
    v_lshlrev_b32 v116, 16, v20
    v_and_b32 v117, s50, v20
    v_lshlrev_b32 v118, 16, v24
    v_and_b32 v119, s50, v24
    v_lshlrev_b32 v120, 16, v28
    v_and_b32 v121, s50, v28
    v_lshlrev_b32 v122, 16, v32
    v_and_b32 v123, s50, v32
    v_lshlrev_b32 v124, 16, v36
    v_and_b32 v125, s50, v36
    v_pk_mul_f32 v[2:3], v[112:113], v[110:111]
    v_pk_mul_f32 v[4:5], v[114:115], v[110:111]
    v_pk_mul_f32 v[8:9], v[116:117], v[110:111]
    v_pk_mul_f32 v[6:7], v[118:119], v[110:111]
    v_pk_fma_f32 v[2:3], v[114:115], v[108:109], v[2:3]
    v_pk_fma_f32 v[4:5], v[116:117], v[108:109], v[4:5]
    v_pk_fma_f32 v[8:9], v[118:119], v[108:109], v[8:9]
    v_pk_fma_f32 v[6:7], v[120:121], v[108:109], v[6:7]
    v_pk_fma_f32 v[2:3], v[116:117], v[106:107], v[2:3]
    v_pk_fma_f32 v[4:5], v[118:119], v[106:107], v[4:5]
    v_pk_fma_f32 v[8:9], v[120:121], v[106:107], v[8:9]
    v_pk_fma_f32 v[6:7], v[122:123], v[106:107], v[6:7]
    v_pk_fma_f32 v[2:3], v[118:119], v[104:105], v[2:3]
    v_pk_fma_f32 v[4:5], v[120:121], v[104:105], v[4:5]
    v_pk_fma_f32 v[8:9], v[122:123], v[104:105], v[8:9]
    v_pk_fma_f32 v[6:7], v[124:125], v[104:105], v[6:7]
    v_lshlrev_b32 v112, 16, v40
    v_and_b32 v113, s50, v40
    v_lshlrev_b32 v114, 16, v44
    v_and_b32 v115, s50, v44
    v_lshlrev_b32 v116, 16, v48
    v_and_b32 v117, s50, v48
    v_lshlrev_b32 v118, 16, v52
    v_and_b32 v119, s50, v52
    v_pk_mul_f32 v[2:3], v[2:3], v[112:113]
    v_pk_mul_f32 v[4:5], v[4:5], v[114:115]
    v_pk_mul_f32 v[8:9], v[8:9], v[116:117]
    v_pk_mul_f32 v[6:7], v[6:7], v[118:119]
    v_cvt_pk_bf16_f32 v120, v6, v8
    v_cvt_pk_bf16_f32 v121, v4, v2
    v_cvt_pk_bf16_f32 v122, v7, v9
    v_cvt_pk_bf16_f32 v123, v5, v3
    ds_write_b64 v10, v[120:121] offset:0
    ds_write_b64 v10, v[122:123] offset:128
    v_lshlrev_b32 v104, 16, v76
    v_and_b32 v106, s50, v76
    v_lshlrev_b32 v108, 16, v77
    v_and_b32 v110, s50, v77
    v_lshlrev_b32 v105, 16, v78
    v_and_b32 v107, s50, v78
    v_lshlrev_b32 v109, 16, v79
    v_and_b32 v111, s50, v79
    v_lshlrev_b32 v112, 16, v13
    v_and_b32 v113, s50, v13
    v_lshlrev_b32 v114, 16, v17
    v_and_b32 v115, s50, v17
    v_lshlrev_b32 v116, 16, v21
    v_and_b32 v117, s50, v21
    v_lshlrev_b32 v118, 16, v25
    v_and_b32 v119, s50, v25
    v_lshlrev_b32 v120, 16, v29
    v_and_b32 v121, s50, v29
    v_lshlrev_b32 v122, 16, v33
    v_and_b32 v123, s50, v33
    v_lshlrev_b32 v124, 16, v37
    v_and_b32 v125, s50, v37
    v_pk_mul_f32 v[2:3], v[112:113], v[110:111]
    v_pk_mul_f32 v[4:5], v[114:115], v[110:111]
    v_pk_mul_f32 v[8:9], v[116:117], v[110:111]
    v_pk_mul_f32 v[6:7], v[118:119], v[110:111]
    v_pk_fma_f32 v[2:3], v[114:115], v[108:109], v[2:3]
    v_pk_fma_f32 v[4:5], v[116:117], v[108:109], v[4:5]
    v_pk_fma_f32 v[8:9], v[118:119], v[108:109], v[8:9]
    v_pk_fma_f32 v[6:7], v[120:121], v[108:109], v[6:7]
    v_pk_fma_f32 v[2:3], v[116:117], v[106:107], v[2:3]
    v_pk_fma_f32 v[4:5], v[118:119], v[106:107], v[4:5]
    v_pk_fma_f32 v[8:9], v[120:121], v[106:107], v[8:9]
    v_pk_fma_f32 v[6:7], v[122:123], v[106:107], v[6:7]
    v_pk_fma_f32 v[2:3], v[118:119], v[104:105], v[2:3]
    v_pk_fma_f32 v[4:5], v[120:121], v[104:105], v[4:5]
    v_pk_fma_f32 v[8:9], v[122:123], v[104:105], v[8:9]
    v_pk_fma_f32 v[6:7], v[124:125], v[104:105], v[6:7]
    v_lshlrev_b32 v112, 16, v41
    v_and_b32 v113, s50, v41
    v_lshlrev_b32 v114, 16, v45
    v_and_b32 v115, s50, v45
    v_lshlrev_b32 v116, 16, v49
    v_and_b32 v117, s50, v49
    v_lshlrev_b32 v118, 16, v53
    v_and_b32 v119, s50, v53
    v_pk_mul_f32 v[2:3], v[2:3], v[112:113]
    v_pk_mul_f32 v[4:5], v[4:5], v[114:115]
    v_pk_mul_f32 v[8:9], v[8:9], v[116:117]
    v_pk_mul_f32 v[6:7], v[6:7], v[118:119]
    v_cvt_pk_bf16_f32 v120, v6, v8
    v_cvt_pk_bf16_f32 v121, v4, v2
    v_cvt_pk_bf16_f32 v122, v7, v9
    v_cvt_pk_bf16_f32 v123, v5, v3
    ds_write_b64 v10, v[120:121] offset:256
    ds_write_b64 v10, v[122:123] offset:384
    v_lshlrev_b32 v104, 16, v80
    v_and_b32 v106, s50, v80
    v_lshlrev_b32 v108, 16, v81
    v_and_b32 v110, s50, v81
    v_lshlrev_b32 v105, 16, v82
    v_and_b32 v107, s50, v82
    v_lshlrev_b32 v109, 16, v83
    v_and_b32 v111, s50, v83
    v_lshlrev_b32 v112, 16, v14
    v_and_b32 v113, s50, v14
    v_lshlrev_b32 v114, 16, v18
    v_and_b32 v115, s50, v18
    v_lshlrev_b32 v116, 16, v22
    v_and_b32 v117, s50, v22
    v_lshlrev_b32 v118, 16, v26
    v_and_b32 v119, s50, v26
    v_lshlrev_b32 v120, 16, v30
    v_and_b32 v121, s50, v30
    v_lshlrev_b32 v122, 16, v34
    v_and_b32 v123, s50, v34
    v_lshlrev_b32 v124, 16, v38
    v_and_b32 v125, s50, v38
    v_pk_mul_f32 v[2:3], v[112:113], v[110:111]
    v_pk_mul_f32 v[4:5], v[114:115], v[110:111]
    v_pk_mul_f32 v[8:9], v[116:117], v[110:111]
    v_pk_mul_f32 v[6:7], v[118:119], v[110:111]
    v_pk_fma_f32 v[2:3], v[114:115], v[108:109], v[2:3]
    v_pk_fma_f32 v[4:5], v[116:117], v[108:109], v[4:5]
    v_pk_fma_f32 v[8:9], v[118:119], v[108:109], v[8:9]
    v_pk_fma_f32 v[6:7], v[120:121], v[108:109], v[6:7]
    v_pk_fma_f32 v[2:3], v[116:117], v[106:107], v[2:3]
    v_pk_fma_f32 v[4:5], v[118:119], v[106:107], v[4:5]
    v_pk_fma_f32 v[8:9], v[120:121], v[106:107], v[8:9]
    v_pk_fma_f32 v[6:7], v[122:123], v[106:107], v[6:7]
    v_pk_fma_f32 v[2:3], v[118:119], v[104:105], v[2:3]
    v_pk_fma_f32 v[4:5], v[120:121], v[104:105], v[4:5]
    v_pk_fma_f32 v[8:9], v[122:123], v[104:105], v[8:9]
    v_pk_fma_f32 v[6:7], v[124:125], v[104:105], v[6:7]
    v_lshlrev_b32 v112, 16, v42
    v_and_b32 v113, s50, v42
    v_lshlrev_b32 v114, 16, v46
    v_and_b32 v115, s50, v46
    v_lshlrev_b32 v116, 16, v50
    v_and_b32 v117, s50, v50
    v_lshlrev_b32 v118, 16, v54
    v_and_b32 v119, s50, v54
    v_pk_mul_f32 v[2:3], v[2:3], v[112:113]
    v_pk_mul_f32 v[4:5], v[4:5], v[114:115]
    v_pk_mul_f32 v[8:9], v[8:9], v[116:117]
    v_pk_mul_f32 v[6:7], v[6:7], v[118:119]
    v_cvt_pk_bf16_f32 v120, v6, v8
    v_cvt_pk_bf16_f32 v121, v4, v2
    v_cvt_pk_bf16_f32 v122, v7, v9
    v_cvt_pk_bf16_f32 v123, v5, v3
    ds_write_b64 v10, v[120:121] offset:512
    ds_write_b64 v10, v[122:123] offset:640
    v_lshlrev_b32 v104, 16, v84
    v_and_b32 v106, s50, v84
    v_lshlrev_b32 v108, 16, v85
    v_and_b32 v110, s50, v85
    v_lshlrev_b32 v105, 16, v86
    v_and_b32 v107, s50, v86
    v_lshlrev_b32 v109, 16, v87
    v_and_b32 v111, s50, v87
    v_lshlrev_b32 v112, 16, v15
    v_and_b32 v113, s50, v15
    v_lshlrev_b32 v114, 16, v19
    v_and_b32 v115, s50, v19
    v_lshlrev_b32 v116, 16, v23
    v_and_b32 v117, s50, v23
    v_lshlrev_b32 v118, 16, v27
    v_and_b32 v119, s50, v27
    v_lshlrev_b32 v120, 16, v31
    v_and_b32 v121, s50, v31
    v_lshlrev_b32 v122, 16, v35
    v_and_b32 v123, s50, v35
    v_lshlrev_b32 v124, 16, v39
    v_and_b32 v125, s50, v39
    v_pk_mul_f32 v[2:3], v[112:113], v[110:111]
    v_pk_mul_f32 v[4:5], v[114:115], v[110:111]
    v_pk_mul_f32 v[8:9], v[116:117], v[110:111]
    v_pk_mul_f32 v[6:7], v[118:119], v[110:111]
    v_pk_fma_f32 v[2:3], v[114:115], v[108:109], v[2:3]
    v_pk_fma_f32 v[4:5], v[116:117], v[108:109], v[4:5]
    v_pk_fma_f32 v[8:9], v[118:119], v[108:109], v[8:9]
    v_pk_fma_f32 v[6:7], v[120:121], v[108:109], v[6:7]
    v_pk_fma_f32 v[2:3], v[116:117], v[106:107], v[2:3]
    v_pk_fma_f32 v[4:5], v[118:119], v[106:107], v[4:5]
    v_pk_fma_f32 v[8:9], v[120:121], v[106:107], v[8:9]
    v_pk_fma_f32 v[6:7], v[122:123], v[106:107], v[6:7]
    v_pk_fma_f32 v[2:3], v[118:119], v[104:105], v[2:3]
    v_pk_fma_f32 v[4:5], v[120:121], v[104:105], v[4:5]
    v_pk_fma_f32 v[8:9], v[122:123], v[104:105], v[8:9]
    v_pk_fma_f32 v[6:7], v[124:125], v[104:105], v[6:7]
    v_lshlrev_b32 v112, 16, v43
    v_and_b32 v113, s50, v43
    v_lshlrev_b32 v114, 16, v47
    v_and_b32 v115, s50, v47
    v_lshlrev_b32 v116, 16, v51
    v_and_b32 v117, s50, v51
    v_lshlrev_b32 v118, 16, v55
    v_and_b32 v119, s50, v55
    v_pk_mul_f32 v[2:3], v[2:3], v[112:113]
    v_pk_mul_f32 v[4:5], v[4:5], v[114:115]
    v_pk_mul_f32 v[8:9], v[8:9], v[116:117]
    v_pk_mul_f32 v[6:7], v[6:7], v[118:119]
    v_cvt_pk_bf16_f32 v120, v6, v8
    v_cvt_pk_bf16_f32 v121, v4, v2
    v_cvt_pk_bf16_f32 v122, v7, v9
    v_cvt_pk_bf16_f32 v123, v5, v3
    ds_write_b64 v10, v[120:121] offset:768
    ds_write_b64 v10, v[122:123] offset:896
    s_waitcnt vmcnt(1)
    v_perm_b32 v12, v60, v56, s48
    v_perm_b32 v13, v68, v64, s48
    ds_write_b64 v11, v[12:13] offset:16384
    v_perm_b32 v14, v60, v56, s49
    v_perm_b32 v15, v68, v64, s49
    ds_write_b64 v11, v[14:15] offset:16512
    v_perm_b32 v16, v61, v57, s48
    v_perm_b32 v17, v69, v65, s48
    ds_write_b64 v11, v[16:17] offset:16640
    v_perm_b32 v18, v61, v57, s49
    v_perm_b32 v19, v69, v65, s49
    ds_write_b64 v11, v[18:19] offset:16768
    v_perm_b32 v20, v62, v58, s48
    v_perm_b32 v21, v70, v66, s48
    ds_write_b64 v11, v[20:21] offset:16896
    v_perm_b32 v22, v62, v58, s49
    v_perm_b32 v23, v70, v66, s49
    ds_write_b64 v11, v[22:23] offset:17024
    v_perm_b32 v24, v63, v59, s48
    v_perm_b32 v25, v71, v67, s48
    ds_write_b64 v11, v[24:25] offset:17152
    v_perm_b32 v26, v63, v59, s49
    v_perm_b32 v27, v71, v67, s49
    ds_write_b64 v11, v[26:27] offset:17280
    v_and_b32 v1, 7, v0
    v_lshrrev_b32 v2, 7, v0
    v_xor_b32 v2, v2, v1
    v_lshrrev_b32 v3, 3, v0
    v_lshlrev_b32 v4, 7, v3
    v_lshl_add_u32 v4, v2, 4, v4
    v_add_u32 v4, 90112, v4
    v_xor_b32 v5, 32, v4
    v_xor_b32 v6, 64, v4
    v_xor_b32 v7, 96, v4
    v_lshlrev_b32 v3, 12, v3
    v_lshl_add_u32 v37, v1, 4, v3
    v_mov_b32 v33, 153676
    v_mov_b32 v34, 1
    s_waitcnt lgkmcnt(0)
    s_cbranch_execz Lsequen_f_kvback
    s_mov_b64 exec, 1
    ds_add_u32 v33, v34
    s_mov_b64 exec, -1
    s_lshl_b32 s4, s41, 19
    s_lshl_b32 s5, s40, 7
    s_add_u32 s4, s4, s5
    s_add_u32 s16, s4, 0x0
    s_add_u32 s17, s4, 0x20000
    s_add_u32 s18, s4, 0x40000
    s_add_u32 s19, s4, 0x60000
    s_add_u32 s20, s4, 0x400000
    s_add_u32 s21, s4, 0x420000
    s_add_u32 s22, s4, 0x440000
    s_add_u32 s23, s4, 0x460000
Lsequen_f_waitT:
    ds_read_b32 v34, v33
    s_waitcnt lgkmcnt(0)
    v_cmp_gt_u32 vcc, 4, v34
    s_cbranch_vccnz Lsequen_f_waitT
    ds_read_b128 v[40:43], v4 offset:0
    ds_read_b128 v[44:47], v5 offset:4096
    ds_read_b128 v[48:51], v6 offset:8192
    ds_read_b128 v[52:55], v7 offset:12288
    ds_read_b128 v[56:59], v4 offset:16384
    ds_read_b128 v[60:63], v5 offset:20480
    ds_read_b128 v[64:67], v6 offset:24576
    ds_read_b128 v[68:71], v7 offset:28672
    s_waitcnt lgkmcnt(7)
    buffer_store_dwordx4 v[40:43], v37, s[32:35], s16 offen
    s_waitcnt lgkmcnt(6)
    buffer_store_dwordx4 v[44:47], v37, s[32:35], s17 offen
    s_waitcnt lgkmcnt(5)
    buffer_store_dwordx4 v[48:51], v37, s[32:35], s18 offen
    s_waitcnt lgkmcnt(4)
    buffer_store_dwordx4 v[52:55], v37, s[32:35], s19 offen
    v_and_b32 v0, 63, v0
    v_and_b32 v5, 15, v0
    v_lshrrev_b32 v6, 4, v0
    s_lshl_b32 s12, s61, 12
    v_lshlrev_b32 v7, 5, v5
    v_lshl_add_u32 v7, v6, 3, v7
    s_add_u32 s29, s12, 0x800000
    v_sub_u32 v33, 7, v5
    v_and_b32 v33, 3, v33
    v_mul_u32_u24 v33, 4160, v33
    v_lshrrev_b32 v34, 2, v5
    v_lshl_add_u32 v33, v34, 3, v33
    v_lshlrev_b32 v34, 4, v6
    v_sub_u32 v33, v33, v34
    s_add_u32 s30, s63, 24
    v_add_u32 v1, s30, v33
    v_lshlrev_b32 v33, 5, v5
    v_add_u32 v33, v33, v34
    s_add_u32 s30, s63, 16672
    v_add_u32 v3, s30, v33
    v_lshrrev_b32 v33, 3, v5
    v_add_u32 v33, 2, v33
    v_and_b32 v34, 7, v5
    v_sub_u32 v34, 7, v34
    v_cmp_eq_u32 vcc, v33, v6
    v_lshrrev_b32 v35, 1, v34
    v_and_b32 v34, 1, v34
    v_cndmask_b32 v35, 9, v35, vcc
    v_lshlrev_b32 v34, 4, v34
    s_and_b32 s31, s61, 1
    s_lshl_b32 s31, s31, 4
    s_lshr_b32 s51, s51, s31
    s_and_b32 s51, s51, 0xffff
    v_mov_b32 v33, s51
    v_lshlrev_b32 v34, v34, v33
    v_cmp_eq_u32 vcc, 0, v35
    s_nop 1
    v_cndmask_b32 v192, 0, v34, vcc
    v_cmp_eq_u32 vcc, 1, v35
    s_nop 1
    v_cndmask_b32 v193, 0, v34, vcc
    v_cmp_eq_u32 vcc, 2, v35
    s_nop 1
    v_cndmask_b32 v194, 0, v34, vcc
    v_cmp_eq_u32 vcc, 3, v35
    s_nop 1
    v_cndmask_b32 v195, 0, v34, vcc
    s_waitcnt vmcnt(0)
    s_mov_b32 s3, 0
Lsequen_f_tagA:
    v_cmp_eq_u32 vcc, 0, v204
    s_cbranch_vccz Lsequen_f_tagA_x
    buffer_load_dwordx2 v[204:205], v207, s[44:47], 0 offen sc1
    s_waitcnt vmcnt(0)
    s_add_u32 s3, s3, 1
    s_cmp_lt_u32 s3, 0x100000
    s_cbranch_scc1 Lsequen_f_tagA
Lsequen_f_tagA_x:
    v_readfirstlane_b32 s98, v204
    v_readfirstlane_b32 s99, v205
    v_mov_b32 v200, 153664
    v_mov_b32 v201, 1
    s_mov_b64 exec, 1
    ds_add_rtn_u32 v202, v200, v201
    s_waitcnt lgkmcnt(0)
    v_readfirstlane_b32 s3, v202
    s_cmp_eq_u32 s3, 3
    s_cbranch_scc0 Lsequen_f_pubU
    s_lshl_b32 s3, s40, 14
    v_mov_b32 v200, s3
    s_add_u32 s3, s39, 0xd00000
    buffer_store_dwordx3 v[204:206], v200, s[32:35], s3 offen
    s_add_u32 s3, s3, 0x80
    buffer_store_dwordx3 v[204:206], v200, s[32:35], s3 offen sc1
Lsequen_f_pubU:
    s_mov_b64 exec, -1
    buffer_store_dwordx4 v[56:59], v37, s[32:35], s20 offen
    buffer_store_dwordx4 v[60:63], v37, s[32:35], s21 offen
    buffer_store_dwordx4 v[64:67], v37, s[32:35], s22 offen
    buffer_store_dwordx4 v[68:71], v37, s[32:35], s23 offen
    s_waitcnt vmcnt(0)
    v_mov_b32 v200, 153668
    v_mov_b32 v201, 1
    s_mov_b64 exec, 1
    ds_add_rtn_u32 v202, v200, v201
    s_waitcnt lgkmcnt(0)
    v_readfirstlane_b32 s3, v202
    s_cmp_eq_u32 s3, 3
    s_cbranch_scc0 Lsequen_f_pubX
    s_lshl_b32 s3, s40, 14
    v_mov_b32 v200, s3
    s_add_u32 s3, s39, 0xd00100
    buffer_store_dwordx3 v[204:206], v200, s[32:35], s3 offen
    s_add_u32 s3, s3, 0x80
    buffer_store_dwordx3 v[204:206], v200, s[32:35], s3 offen sc1
Lsequen_f_pubX:
    s_mov_b64 exec, -1
    s_lshl_b32 s3, s60, 2
    s_add_u32 s3, s3, 153696
    v_mov_b32 v33, s3
Lsequen_f_waitK:
    ds_read_b32 v34, v33
    s_waitcnt lgkmcnt(0)
    v_cmp_eq_u32 vcc, 0, v34
    s_cbranch_vccnz Lsequen_f_waitK
    ds_read_b64 v[64:65], v1 offset:32
    ds_read_b64 v[66:67], v1 offset:40
    ds_read_b64 v[68:69], v1 offset:544
    ds_read_b64 v[70:71], v1 offset:552
    ds_read_b64 v[72:73], v1 offset:1056
    ds_read_b64 v[74:75], v1 offset:1064
    ds_read_b64 v[76:77], v1 offset:1568
    ds_read_b64 v[78:79], v1 offset:1576
    ds_read_b64 v[80:81], v1 offset:2080
    ds_read_b64 v[82:83], v1 offset:2088
    ds_read_b64 v[84:85], v1 offset:2592
    ds_read_b64 v[86:87], v1 offset:2600
    ds_read_b64 v[88:89], v1 offset:3104
    ds_read_b64 v[90:91], v1 offset:3112
    ds_read_b64 v[92:93], v1 offset:3616
    ds_read_b64 v[94:95], v1 offset:3624
Lsequen_f_waitU:
    ds_read_b32 v34, v33
    s_waitcnt lgkmcnt(0)
    v_cmp_gt_u32 vcc, 2, v34
    s_cbranch_vccnz Lsequen_f_waitU
    ds_read_b128 v[96:99], v3 offset:448
    ds_read_b128 v[100:103], v3 offset:960
    ds_read_b128 v[104:107], v3 offset:1472
    ds_read_b128 v[108:111], v3 offset:1984
    ds_read_b128 v[112:115], v3 offset:2496
    ds_read_b128 v[116:119], v3 offset:3008
    ds_read_b128 v[120:123], v3 offset:3520
    ds_read_b128 v[124:127], v3 offset:4032
    s_waitcnt lgkmcnt(7)
    v_mfma_f32_16x16x32_bf16 v[8:11], v[192:195], v[96:99], 0
    s_waitcnt lgkmcnt(6)
    v_mfma_f32_16x16x32_bf16 v[12:15], v[192:195], v[100:103], 0
    s_waitcnt lgkmcnt(5)
    v_mfma_f32_16x16x32_bf16 v[16:19], v[192:195], v[104:107], 0
    s_waitcnt lgkmcnt(4)
    v_mfma_f32_16x16x32_bf16 v[20:23], v[192:195], v[108:111], 0
    s_waitcnt lgkmcnt(3)
    v_mfma_f32_16x16x32_bf16 v[24:27], v[192:195], v[112:115], 0
    s_waitcnt lgkmcnt(2)
    v_mfma_f32_16x16x32_bf16 v[28:31], v[192:195], v[116:119], 0
    s_waitcnt lgkmcnt(1)
    v_mfma_f32_16x16x32_bf16 v[32:35], v[192:195], v[120:123], 0
    s_waitcnt lgkmcnt(0)
    v_mfma_f32_16x16x32_bf16 v[36:39], v[192:195], v[124:127], 0
    s_mov_b32 s26, 0
Lsequen_f_loop:
    s_waitcnt lgkmcnt(0)
    v_mfma_f32_16x16x32_bf16 v[8:11], v[64:67], v[96:99], v[8:11]
    ds_read_b128 v[160:163], v3 offset:384
    v_mfma_f32_16x16x32_bf16 v[12:15], v[64:67], v[100:103], v[12:15]
    ds_read_b128 v[164:167], v3 offset:896
    v_mfma_f32_16x16x32_bf16 v[16:19], v[64:67], v[104:107], v[16:19]
    ds_read_b128 v[168:171], v3 offset:1408
    v_mfma_f32_16x16x32_bf16 v[20:23], v[64:67], v[108:111], v[20:23]
    ds_read_b128 v[172:175], v3 offset:1920
    v_mfma_f32_16x16x32_bf16 v[24:27], v[64:67], v[112:115], v[24:27]
    ds_read_b128 v[176:179], v3 offset:2432
    v_mfma_f32_16x16x32_bf16 v[28:31], v[64:67], v[116:119], v[28:31]
    ds_read_b128 v[180:183], v3 offset:2944
    v_mfma_f32_16x16x32_bf16 v[32:35], v[64:67], v[120:123], v[32:35]
    ds_read_b128 v[184:187], v3 offset:3456
    v_mfma_f32_16x16x32_bf16 v[36:39], v[64:67], v[124:127], v[36:39]
    ds_read_b128 v[188:191], v3 offset:3968
    v_mfma_f32_16x16x32_bf16 v[12:15], v[68:71], v[96:99], v[12:15]
    ds_read_b64 v[128:129], v1 offset:96
    v_mfma_f32_16x16x32_bf16 v[16:19], v[68:71], v[100:103], v[16:19]
    ds_read_b64 v[130:131], v1 offset:104
    v_mfma_f32_16x16x32_bf16 v[20:23], v[68:71], v[104:107], v[20:23]
    ds_read_b64 v[132:133], v1 offset:608
    v_mfma_f32_16x16x32_bf16 v[24:27], v[68:71], v[108:111], v[24:27]
    ds_read_b64 v[134:135], v1 offset:616
    v_mfma_f32_16x16x32_bf16 v[28:31], v[68:71], v[112:115], v[28:31]
    ds_read_b64 v[136:137], v1 offset:1120
    v_mfma_f32_16x16x32_bf16 v[32:35], v[68:71], v[116:119], v[32:35]
    ds_read_b64 v[138:139], v1 offset:1128
    v_mfma_f32_16x16x32_bf16 v[36:39], v[68:71], v[120:123], v[36:39]
    ds_read_b64 v[140:141], v1 offset:1632
    v_mfma_f32_16x16x32_bf16 v[16:19], v[72:75], v[96:99], v[16:19]
    ds_read_b64 v[142:143], v1 offset:1640
    v_mfma_f32_16x16x32_bf16 v[20:23], v[72:75], v[100:103], v[20:23]
    ds_read_b64 v[144:145], v1 offset:2144
    v_mfma_f32_16x16x32_bf16 v[24:27], v[72:75], v[104:107], v[24:27]
    ds_read_b64 v[146:147], v1 offset:2152
    v_mfma_f32_16x16x32_bf16 v[28:31], v[72:75], v[108:111], v[28:31]
    ds_read_b64 v[148:149], v1 offset:2656
    v_mfma_f32_16x16x32_bf16 v[32:35], v[72:75], v[112:115], v[32:35]
    ds_read_b64 v[150:151], v1 offset:2664
    v_mfma_f32_16x16x32_bf16 v[36:39], v[72:75], v[116:119], v[36:39]
    ds_read_b64 v[152:153], v1 offset:3168
    v_mfma_f32_16x16x32_bf16 v[20:23], v[76:79], v[96:99], v[20:23]
    ds_read_b64 v[154:155], v1 offset:3176
    v_mfma_f32_16x16x32_bf16 v[24:27], v[76:79], v[100:103], v[24:27]
    ds_read_b64 v[156:157], v1 offset:3680
    v_mfma_f32_16x16x32_bf16 v[28:31], v[76:79], v[104:107], v[28:31]
    ds_read_b64 v[158:159], v1 offset:3688
    v_mfma_f32_16x16x32_bf16 v[32:35], v[76:79], v[108:111], v[32:35]
    v_mfma_f32_16x16x32_bf16 v[36:39], v[76:79], v[112:115], v[36:39]
    v_mfma_f32_16x16x32_bf16 v[24:27], v[80:83], v[96:99], v[24:27]
    v_mfma_f32_16x16x32_bf16 v[28:31], v[80:83], v[100:103], v[28:31]
    v_mfma_f32_16x16x32_bf16 v[32:35], v[80:83], v[104:107], v[32:35]
    v_mfma_f32_16x16x32_bf16 v[36:39], v[80:83], v[108:111], v[36:39]
    v_mfma_f32_16x16x32_bf16 v[28:31], v[84:87], v[96:99], v[28:31]
    v_mfma_f32_16x16x32_bf16 v[32:35], v[84:87], v[100:103], v[32:35]
    v_mfma_f32_16x16x32_bf16 v[36:39], v[84:87], v[104:107], v[36:39]
    v_mfma_f32_16x16x32_bf16 v[32:35], v[88:91], v[96:99], v[32:35]
    v_mfma_f32_16x16x32_bf16 v[36:39], v[88:91], v[100:103], v[36:39]
    v_mfma_f32_16x16x32_bf16 v[36:39], v[92:95], v[96:99], v[36:39]
    s_waitcnt lgkmcnt(0)
    v_mfma_f32_16x16x32_bf16 v[8:11], v[128:131], v[160:163], v[8:11]
    ds_read_b128 v[96:99], v3 offset:320
    v_mfma_f32_16x16x32_bf16 v[12:15], v[128:131], v[164:167], v[12:15]
    ds_read_b128 v[100:103], v3 offset:832
    v_mfma_f32_16x16x32_bf16 v[16:19], v[128:131], v[168:171], v[16:19]
    ds_read_b128 v[104:107], v3 offset:1344
    v_mfma_f32_16x16x32_bf16 v[20:23], v[128:131], v[172:175], v[20:23]
    ds_read_b128 v[108:111], v3 offset:1856
    v_mfma_f32_16x16x32_bf16 v[24:27], v[128:131], v[176:179], v[24:27]
    ds_read_b128 v[112:115], v3 offset:2368
    v_mfma_f32_16x16x32_bf16 v[28:31], v[128:131], v[180:183], v[28:31]
    ds_read_b128 v[116:119], v3 offset:2880
    v_mfma_f32_16x16x32_bf16 v[32:35], v[128:131], v[184:187], v[32:35]
    ds_read_b128 v[120:123], v3 offset:3392
    v_mfma_f32_16x16x32_bf16 v[36:39], v[128:131], v[188:191], v[36:39]
    ds_read_b128 v[124:127], v3 offset:3904
    v_mfma_f32_16x16x32_bf16 v[12:15], v[132:135], v[160:163], v[12:15]
    ds_read_b64 v[64:65], v1 offset:160
    v_mfma_f32_16x16x32_bf16 v[16:19], v[132:135], v[164:167], v[16:19]
    ds_read_b64 v[66:67], v1 offset:168
    v_mfma_f32_16x16x32_bf16 v[20:23], v[132:135], v[168:171], v[20:23]
    ds_read_b64 v[68:69], v1 offset:672
    v_mfma_f32_16x16x32_bf16 v[24:27], v[132:135], v[172:175], v[24:27]
    ds_read_b64 v[70:71], v1 offset:680
    v_mfma_f32_16x16x32_bf16 v[28:31], v[132:135], v[176:179], v[28:31]
    ds_read_b64 v[72:73], v1 offset:1184
    v_mfma_f32_16x16x32_bf16 v[32:35], v[132:135], v[180:183], v[32:35]
    ds_read_b64 v[74:75], v1 offset:1192
    v_mfma_f32_16x16x32_bf16 v[36:39], v[132:135], v[184:187], v[36:39]
    ds_read_b64 v[76:77], v1 offset:1696
    v_mfma_f32_16x16x32_bf16 v[16:19], v[136:139], v[160:163], v[16:19]
    ds_read_b64 v[78:79], v1 offset:1704
    v_mfma_f32_16x16x32_bf16 v[20:23], v[136:139], v[164:167], v[20:23]
    ds_read_b64 v[80:81], v1 offset:2208
    v_mfma_f32_16x16x32_bf16 v[24:27], v[136:139], v[168:171], v[24:27]
    ds_read_b64 v[82:83], v1 offset:2216
    v_mfma_f32_16x16x32_bf16 v[28:31], v[136:139], v[172:175], v[28:31]
    ds_read_b64 v[84:85], v1 offset:2720
    v_mfma_f32_16x16x32_bf16 v[32:35], v[136:139], v[176:179], v[32:35]
    ds_read_b64 v[86:87], v1 offset:2728
    v_mfma_f32_16x16x32_bf16 v[36:39], v[136:139], v[180:183], v[36:39]
    ds_read_b64 v[88:89], v1 offset:3232
    v_mfma_f32_16x16x32_bf16 v[20:23], v[140:143], v[160:163], v[20:23]
    ds_read_b64 v[90:91], v1 offset:3240
    v_mfma_f32_16x16x32_bf16 v[24:27], v[140:143], v[164:167], v[24:27]
    ds_read_b64 v[92:93], v1 offset:3744
    v_mfma_f32_16x16x32_bf16 v[28:31], v[140:143], v[168:171], v[28:31]
    ds_read_b64 v[94:95], v1 offset:3752
    v_mfma_f32_16x16x32_bf16 v[32:35], v[140:143], v[172:175], v[32:35]
    v_mfma_f32_16x16x32_bf16 v[36:39], v[140:143], v[176:179], v[36:39]
    v_mfma_f32_16x16x32_bf16 v[24:27], v[144:147], v[160:163], v[24:27]
    v_mfma_f32_16x16x32_bf16 v[28:31], v[144:147], v[164:167], v[28:31]
    v_mfma_f32_16x16x32_bf16 v[32:35], v[144:147], v[168:171], v[32:35]
    v_mfma_f32_16x16x32_bf16 v[36:39], v[144:147], v[172:175], v[36:39]
    v_mfma_f32_16x16x32_bf16 v[28:31], v[148:151], v[160:163], v[28:31]
    v_mfma_f32_16x16x32_bf16 v[32:35], v[148:151], v[164:167], v[32:35]
    v_mfma_f32_16x16x32_bf16 v[36:39], v[148:151], v[168:171], v[36:39]
    v_mfma_f32_16x16x32_bf16 v[32:35], v[152:155], v[160:163], v[32:35]
    v_mfma_f32_16x16x32_bf16 v[36:39], v[152:155], v[164:167], v[36:39]
    v_mfma_f32_16x16x32_bf16 v[36:39], v[156:159], v[160:163], v[36:39]
    v_add_u32 v1, 128, v1
    v_add_u32 v3, -128, v3
    s_add_u32 s26, s26, 1
    s_cmp_lt_u32 s26, 4
    s_cbranch_scc1 Lsequen_f_loop
    v_lshlrev_b32 v1, 6, v5
    v_lshl_add_u32 v1, v6, 4, v1
    v_add_u32 v1, 135168, v1
    s_lshl_b32 s26, s60, 12
    s_add_u32 s26, s26, 90112
    v_add_u32 v2, s26, v7
    v_mov_b32 v3, 153680
    v_and_b32 v4, 1, v6
    v_lshlrev_b32 v4, 9, v4
    v_lshl_add_u32 v4, v5, 5, v4
    v_lshrrev_b32 v200, 1, v6
    v_lshl_add_u32 v4, v200, 4, v4
Lsequen_f_spoll:
    ds_read_b64 v[64:65], v3
    s_waitcnt lgkmcnt(0)
    v_and_b32 v64, v64, v65
    v_cmp_eq_u32 vcc, 0, v64
    s_cbranch_vccnz Lsequen_f_spoll
    ds_read_b64 v[176:177], v2 offset:0
    ds_read_b64 v[178:179], v2 offset:512
    ds_read_b64 v[180:181], v2 offset:1024
    ds_read_b64 v[182:183], v2 offset:1536
    ds_read_b64 v[184:185], v2 offset:2048
    ds_read_b64 v[186:187], v2 offset:2560
    ds_read_b64 v[188:189], v2 offset:3072
    ds_read_b64 v[190:191], v2 offset:3584
    ds_read_b128 v[64:67], v1 offset:0
    ds_read_b128 v[96:99], v1 offset:8192
    ds_read_b128 v[68:71], v1 offset:1024
    ds_read_b128 v[100:103], v1 offset:9216
    ds_read_b128 v[72:75], v1 offset:2048
    ds_read_b128 v[104:107], v1 offset:10240
    s_waitcnt lgkmcnt(6)
    ds_read_b128 v[76:79], v1 offset:3072
    ds_read_b128 v[108:111], v1 offset:11264
    v_lshlrev_b32 v128, 16, v176
    v_and_b32 v129, s50, v176
    v_lshlrev_b32 v130, 16, v177
    v_and_b32 v131, s50, v177
    s_waitcnt lgkmcnt(6)
    v_pk_add_f32 v[132:133], v[128:129], v[64:65] neg_lo:[0,1] neg_hi:[0,1]
    v_pk_add_f32 v[134:135], v[130:131], v[66:67] neg_lo:[0,1] neg_hi:[0,1]
    v_pk_mul_f32 v[132:133], v[132:133], v[96:97]
    v_pk_mul_f32 v[134:135], v[134:135], v[98:99]
    v_pk_fma_f32 v[132:133], v[132:133], v[8:9], v[128:129]
    v_pk_fma_f32 v[134:135], v[134:135], v[10:11], v[130:131]
    v_cvt_pk_bf16_f32 v176, v132, v133
    v_cvt_pk_bf16_f32 v177, v134, v135
    ds_read_b128 v[80:83], v1 offset:4096
    ds_read_b128 v[112:115], v1 offset:12288
    v_lshlrev_b32 v136, 16, v178
    v_and_b32 v137, s50, v178
    v_lshlrev_b32 v138, 16, v179
    v_and_b32 v139, s50, v179
    s_waitcnt lgkmcnt(6)
    v_pk_add_f32 v[140:141], v[136:137], v[68:69] neg_lo:[0,1] neg_hi:[0,1]
    v_pk_add_f32 v[142:143], v[138:139], v[70:71] neg_lo:[0,1] neg_hi:[0,1]
    v_pk_mul_f32 v[140:141], v[140:141], v[100:101]
    v_pk_mul_f32 v[142:143], v[142:143], v[102:103]
    v_pk_fma_f32 v[140:141], v[140:141], v[12:13], v[136:137]
    v_pk_fma_f32 v[142:143], v[142:143], v[14:15], v[138:139]
    v_cvt_pk_bf16_f32 v178, v140, v141
    v_cvt_pk_bf16_f32 v179, v142, v143
    s_nop 1
    v_permlane16_swap_b32 v176, v178
    v_permlane16_swap_b32 v177, v179
    buffer_store_dwordx4 v[176:179], v4, s[32:35], s29 offen offset:0 sc1
    ds_read_b128 v[84:87], v1 offset:5120
    ds_read_b128 v[116:119], v1 offset:13312
    v_lshlrev_b32 v128, 16, v180
    v_and_b32 v129, s50, v180
    v_lshlrev_b32 v130, 16, v181
    v_and_b32 v131, s50, v181
    s_waitcnt lgkmcnt(6)
    v_pk_add_f32 v[132:133], v[128:129], v[72:73] neg_lo:[0,1] neg_hi:[0,1]
    v_pk_add_f32 v[134:135], v[130:131], v[74:75] neg_lo:[0,1] neg_hi:[0,1]
    v_pk_mul_f32 v[132:133], v[132:133], v[104:105]
    v_pk_mul_f32 v[134:135], v[134:135], v[106:107]
    v_pk_fma_f32 v[132:133], v[132:133], v[16:17], v[128:129]
    v_pk_fma_f32 v[134:135], v[134:135], v[18:19], v[130:131]
    v_cvt_pk_bf16_f32 v180, v132, v133
    v_cvt_pk_bf16_f32 v181, v134, v135
    ds_read_b128 v[88:91], v1 offset:6144
    ds_read_b128 v[120:123], v1 offset:14336
    v_lshlrev_b32 v136, 16, v182
    v_and_b32 v137, s50, v182
    v_lshlrev_b32 v138, 16, v183
    v_and_b32 v139, s50, v183
    s_waitcnt lgkmcnt(6)
    v_pk_add_f32 v[140:141], v[136:137], v[76:77] neg_lo:[0,1] neg_hi:[0,1]
    v_pk_add_f32 v[142:143], v[138:139], v[78:79] neg_lo:[0,1] neg_hi:[0,1]
    v_pk_mul_f32 v[140:141], v[140:141], v[108:109]
    v_pk_mul_f32 v[142:143], v[142:143], v[110:111]
    v_pk_fma_f32 v[140:141], v[140:141], v[20:21], v[136:137]
    v_pk_fma_f32 v[142:143], v[142:143], v[22:23], v[138:139]
    v_cvt_pk_bf16_f32 v182, v140, v141
    v_cvt_pk_bf16_f32 v183, v142, v143
    s_nop 1
    v_permlane16_swap_b32 v180, v182
    v_permlane16_swap_b32 v181, v183
    buffer_store_dwordx4 v[180:183], v4, s[32:35], s29 offen offset:1024 sc1
    ds_read_b128 v[92:95], v1 offset:7168
    ds_read_b128 v[124:127], v1 offset:15360
    v_lshlrev_b32 v128, 16, v184
    v_and_b32 v129, s50, v184
    v_lshlrev_b32 v130, 16, v185
    v_and_b32 v131, s50, v185
    s_waitcnt lgkmcnt(6)
    v_pk_add_f32 v[132:133], v[128:129], v[80:81] neg_lo:[0,1] neg_hi:[0,1]
    v_pk_add_f32 v[134:135], v[130:131], v[82:83] neg_lo:[0,1] neg_hi:[0,1]
    v_pk_mul_f32 v[132:133], v[132:133], v[112:113]
    v_pk_mul_f32 v[134:135], v[134:135], v[114:115]
    v_pk_fma_f32 v[132:133], v[132:133], v[24:25], v[128:129]
    v_pk_fma_f32 v[134:135], v[134:135], v[26:27], v[130:131]
    v_cvt_pk_bf16_f32 v184, v132, v133
    v_cvt_pk_bf16_f32 v185, v134, v135
    v_lshlrev_b32 v136, 16, v186
    v_and_b32 v137, s50, v186
    v_lshlrev_b32 v138, 16, v187
    v_and_b32 v139, s50, v187
    s_waitcnt lgkmcnt(4)
    v_pk_add_f32 v[140:141], v[136:137], v[84:85] neg_lo:[0,1] neg_hi:[0,1]
    v_pk_add_f32 v[142:143], v[138:139], v[86:87] neg_lo:[0,1] neg_hi:[0,1]
    v_pk_mul_f32 v[140:141], v[140:141], v[116:117]
    v_pk_mul_f32 v[142:143], v[142:143], v[118:119]
    v_pk_fma_f32 v[140:141], v[140:141], v[28:29], v[136:137]
    v_pk_fma_f32 v[142:143], v[142:143], v[30:31], v[138:139]
    v_cvt_pk_bf16_f32 v186, v140, v141
    v_cvt_pk_bf16_f32 v187, v142, v143
    s_nop 1
    v_permlane16_swap_b32 v184, v186
    v_permlane16_swap_b32 v185, v187
    buffer_store_dwordx4 v[184:187], v4, s[32:35], s29 offen offset:2048 sc1
    v_lshlrev_b32 v128, 16, v188
    v_and_b32 v129, s50, v188
    v_lshlrev_b32 v130, 16, v189
    v_and_b32 v131, s50, v189
    s_waitcnt lgkmcnt(2)
    v_pk_add_f32 v[132:133], v[128:129], v[88:89] neg_lo:[0,1] neg_hi:[0,1]
    v_pk_add_f32 v[134:135], v[130:131], v[90:91] neg_lo:[0,1] neg_hi:[0,1]
    v_pk_mul_f32 v[132:133], v[132:133], v[120:121]
    v_pk_mul_f32 v[134:135], v[134:135], v[122:123]
    v_pk_fma_f32 v[132:133], v[132:133], v[32:33], v[128:129]
    v_pk_fma_f32 v[134:135], v[134:135], v[34:35], v[130:131]
    v_cvt_pk_bf16_f32 v188, v132, v133
    v_cvt_pk_bf16_f32 v189, v134, v135
    v_lshlrev_b32 v136, 16, v190
    v_and_b32 v137, s50, v190
    v_lshlrev_b32 v138, 16, v191
    v_and_b32 v139, s50, v191
    s_waitcnt lgkmcnt(0)
    v_pk_add_f32 v[140:141], v[136:137], v[92:93] neg_lo:[0,1] neg_hi:[0,1]
    v_pk_add_f32 v[142:143], v[138:139], v[94:95] neg_lo:[0,1] neg_hi:[0,1]
    v_pk_mul_f32 v[140:141], v[140:141], v[124:125]
    v_pk_mul_f32 v[142:143], v[142:143], v[126:127]
    v_pk_fma_f32 v[140:141], v[140:141], v[36:37], v[136:137]
    v_pk_fma_f32 v[142:143], v[142:143], v[38:39], v[138:139]
    v_cvt_pk_bf16_f32 v190, v140, v141
    v_cvt_pk_bf16_f32 v191, v142, v143
    s_nop 1
    v_permlane16_swap_b32 v188, v190
    v_permlane16_swap_b32 v189, v191
    buffer_store_dwordx4 v[188:191], v4, s[32:35], s29 offen offset:3072 sc1
    v_mov_b32 v200, 153712
    v_mov_b32 v201, 1
    s_waitcnt lgkmcnt(0)
    s_mov_b64 exec, 1
    ds_add_u32 v200, v201
    s_mov_b64 exec, -1
    s_mov_b64 exec, -1
    v_mov_b32 v200, 153716
    v_mov_b32 v201, 1
    s_waitcnt vmcnt(0)
    s_mov_b64 exec, 1
    ds_add_rtn_u32 v202, v200, v201
    s_waitcnt lgkmcnt(0)
    v_readfirstlane_b32 s3, v202
    s_cmp_eq_u32 s3, 7
    s_cbranch_scc0 Lsequen_f_finA
    s_lshl_b32 s3, s2, 11
    s_add_u32 s3, s3, 0xd00280
    buffer_store_dwordx2 v[204:205], v207, s[32:35], s3 offen sc1
Lsequen_f_finA:
    s_mov_b64 exec, -1
    s_branch Lmlp_compute
Lsequen_f_bwave:
    s_setprio 3
    v_and_b32 v0, 63, v0
    v_lshlrev_b32 v2, 4, v0
    v_mov_b32 v36, 0
    v_mov_b32 v37, 0
    v_mov_b32 v38, 0
    v_mov_b32 v39, 0
    v_min_u32 v33, 48, v2
    v_add_u32 v33, 153664, v33
    ds_write_b128 v33, v[36:39]
    s_memrealtime s[48:49]
    s_waitcnt lgkmcnt(0)
    s_mov_b32 s44, s52
    s_and_b32 s45, s53, 0xffff
    s_mov_b32 s46, 0x100
    s_mov_b32 s47, 0x20000
    s_or_b32 s48, s48, 1
    s_add_u32 s3, s2, s62
    s_cmp_eq_u32 s3, 0
    s_cbranch_scc0 Lsequen_f_notag
    v_mov_b32 v40, s48
    v_mov_b32 v41, s49
    s_mov_b64 exec, 1
    buffer_store_dwordx2 v[40:41], v207, s[44:47], 0 offen sc1
    s_mov_b64 exec, -1
Lsequen_f_notag:
    s_setprio 0
    v_add_u32 v3, -8, v2
    v_add_u32 v4, 1016, v2
    s_lshl_b32 s42, s61, 12
    s_add_u32 s20, s12, s42
    s_addc_u32 s21, s13, 0
    s_and_b32 s21, s21, 0xffff
    s_mov_b32 s22, 4096
    s_mov_b32 s23, 0x20000
    s_mov_b32 s16, s4
    s_and_b32 s17, s5, 0xffff
    s_mov_b32 s18, 0x400000
    s_mov_b32 s19, 0x20000
    s_mov_b32 s32, s54
    s_and_b32 s33, s55, 0xffff
    s_mov_b32 s34, 0x10000000
    s_mov_b32 s35, 0x20000
    s_lshl_b32 s43, s2, 14
    s_lshl_b32 s3, s62, 12
    s_add_u32 s43, s43, s3
    v_bfe_u32 v32, v0, 1, 2
    v_mul_u32_u24 v32, 4160, v32
    v_and_b32 v33, 1, v0
    v_lshl_add_u32 v32, v33, 4, v32
    v_add_u32 v33, 16640, v2
    v_cmp_gt_u32 vcc, 32, v0
    s_nop 1
    v_cndmask_b32 v32, v32, v33, vcc
    v_add_u32 v32, s63, v32
    ds_write_b128 v32, v[36:39]
Lsequen_f_kvback:
    s_mov_b64 exec, -1
    s_barrier
    s_lshl_b32 s3, s2, 11
    s_add_u32 s3, s3, 0xd00000
    s_lshr_b32 s24, s41, 1
    s_lshl_b32 s24, s24, 2
    s_and_b32 s25, s40, 3
    s_add_u32 s24, s24, s25
    s_and_b32 s25, s41, 1
    s_lshl_b32 s25, s25, 3
    s_lshr_b32 s26, s40, 2
    s_add_u32 s25, s25, s26
    s_lshl_b32 s26, s24, 4
    s_add_u32 s26, s26, s25
    s_lshl_b32 s26, s26, 11
    s_add_u32 s26, s26, 0xe00000
    s_lshl_b32 s25, s25, 4
    s_add_u32 s25, s25, s24
    s_lshl_b32 s25, s25, 11
    s_add_u32 s25, s25, 0xe80000
    s_lshl_b32 s24, s2, 6
    s_add_u32 s24, s24, 0xf00000
    s_cmp_eq_u32 s62, 1
    s_cselect_b32 s3, s26, s3
    s_cmp_eq_u32 s62, 2
    s_cselect_b32 s3, s25, s3
    s_cmp_eq_u32 s62, 3
    s_cselect_b32 s3, s24, s3
    s_cselect_b64 exec, 1, 0xffff
    v_lshlrev_b32 v32, 7, v0
    buffer_load_dword v211, v32, s[32:35], s3 offen
    s_mov_b64 exec, -1
    v_mov_b32 v33, 153688
Lsequen_f_waitL:
    s_sleep 1
    ds_read_b32 v34, v33
    s_waitcnt lgkmcnt(0)
    v_cmp_eq_u32 vcc, 0, v34
    s_cbranch_vccnz Lsequen_f_waitL
    buffer_load_dwordx4 v[8:11], v2, s[20:23], 0 offen offset:0 nt
    buffer_load_dwordx2 v[24:25], v3, s[20:23], 0 offen nt
    buffer_load_dwordx4 v[12:15], v2, s[20:23], 0 offen offset:1024 nt
    buffer_load_dwordx2 v[26:27], v4, s[20:23], 0 offen offset:0 nt
    buffer_load_dwordx4 v[16:19], v2, s[20:23], 0 offen offset:2048 nt
    buffer_load_dwordx2 v[28:29], v4, s[20:23], 0 offen offset:1024 nt
    buffer_load_dwordx4 v[20:23], v2, s[20:23], 0 offen offset:3072 nt
    buffer_load_dwordx2 v[30:31], v4, s[20:23], 0 offen offset:2048 nt
    buffer_load_dwordx4 v[88:91], v2, s[16:19], s43 offen offset:0 nt
    buffer_load_dwordx4 v[92:95], v2, s[16:19], s43 offen offset:1024 nt
    buffer_load_dwordx4 v[96:99], v2, s[16:19], s43 offen offset:2048 nt
    buffer_load_dwordx4 v[100:103], v2, s[16:19], s43 offen offset:3072 nt
    buffer_load_dwordx2 v[204:205], v207, s[44:47], 0 offen sc1
    s_add_u32 s30, s63, 32
    v_add_u32 v4, s30, v2
    s_waitcnt vmcnt(11)
    ds_write_b128 v4, v[8:11] offset:0
    v_mov_b32 v44, v25
    v_mov_b32 v45, v8
    v_mov_b32 v46, v9
    v_mov_b32 v47, v10
    ds_write_b128 v4, v[44:47] offset:8320
    v_alignbit_b32 v48, v8, v25, 16
    v_alignbit_b32 v49, v9, v8, 16
    v_alignbit_b32 v50, v10, v9, 16
    v_alignbit_b32 v51, v11, v10, 16
    ds_write_b128 v4, v[48:51] offset:4160
    v_alignbit_b32 v52, v25, v24, 16
    v_mov_b32 v53, v48
    v_mov_b32 v54, v49
    v_mov_b32 v55, v50
    ds_write_b128 v4, v[52:55] offset:12480
    s_waitcnt vmcnt(9)
    ds_write_b128 v4, v[12:15] offset:1024
    v_mov_b32 v56, v27
    v_mov_b32 v57, v12
    v_mov_b32 v58, v13
    v_mov_b32 v59, v14
    ds_write_b128 v4, v[56:59] offset:9344
    v_alignbit_b32 v60, v12, v27, 16
    v_alignbit_b32 v61, v13, v12, 16
    v_alignbit_b32 v62, v14, v13, 16
    v_alignbit_b32 v63, v15, v14, 16
    ds_write_b128 v4, v[60:63] offset:5184
    v_alignbit_b32 v64, v27, v26, 16
    v_mov_b32 v65, v60
    v_mov_b32 v66, v61
    v_mov_b32 v67, v62
    ds_write_b128 v4, v[64:67] offset:13504
    s_waitcnt vmcnt(7)
    ds_write_b128 v4, v[16:19] offset:2048
    v_mov_b32 v44, v29
    v_mov_b32 v45, v16
    v_mov_b32 v46, v17
    v_mov_b32 v47, v18
    ds_write_b128 v4, v[44:47] offset:10368
    v_alignbit_b32 v48, v16, v29, 16
    v_alignbit_b32 v49, v17, v16, 16
    v_alignbit_b32 v50, v18, v17, 16
    v_alignbit_b32 v51, v19, v18, 16
    ds_write_b128 v4, v[48:51] offset:6208
    v_alignbit_b32 v52, v29, v28, 16
    v_mov_b32 v53, v48
    v_mov_b32 v54, v49
    v_mov_b32 v55, v50
    ds_write_b128 v4, v[52:55] offset:14528
    s_waitcnt vmcnt(5)
    ds_write_b128 v4, v[20:23] offset:3072
    v_mov_b32 v56, v31
    v_mov_b32 v57, v20
    v_mov_b32 v58, v21
    v_mov_b32 v59, v22
    ds_write_b128 v4, v[56:59] offset:11392
    v_alignbit_b32 v60, v20, v31, 16
    v_alignbit_b32 v61, v21, v20, 16
    v_alignbit_b32 v62, v22, v21, 16
    v_alignbit_b32 v63, v23, v22, 16
    ds_write_b128 v4, v[60:63] offset:7232
    v_alignbit_b32 v64, v31, v30, 16
    v_mov_b32 v65, v60
    v_mov_b32 v66, v61
    v_mov_b32 v67, v62
    ds_write_b128 v4, v[64:67] offset:15552
    s_lshl_b32 s3, s62, 2
    s_add_u32 s3, s3, 153696
    v_mov_b32 v33, s3
    v_mov_b32 v34, 1
    s_waitcnt lgkmcnt(0)
    ds_write_b32 v33, v34
    v_mov_b32 v104, 0
    v_mov_b32 v105, 0
    v_mov_b32 v106, 0
    v_mov_b32 v107, 0
    s_mov_b32 s48, 0x3f803f80
    s_waitcnt vmcnt(0)
    v_dot2c_f32_bf16 v104, s48, v88
    v_dot2c_f32_bf16 v106, v88, v88
    v_dot2c_f32_bf16 v105, s48, v96
    v_dot2c_f32_bf16 v107, v96, v96
    v_dot2c_f32_bf16 v104, s48, v89
    v_dot2c_f32_bf16 v106, v89, v89
    v_dot2c_f32_bf16 v105, s48, v97
    v_dot2c_f32_bf16 v107, v97, v97
    v_dot2c_f32_bf16 v104, s48, v90
    v_dot2c_f32_bf16 v106, v90, v90
    v_dot2c_f32_bf16 v105, s48, v98
    v_dot2c_f32_bf16 v107, v98, v98
    v_dot2c_f32_bf16 v104, s48, v91
    v_dot2c_f32_bf16 v106, v91, v91
    v_dot2c_f32_bf16 v105, s48, v99
    v_dot2c_f32_bf16 v107, v99, v99
    v_dot2c_f32_bf16 v104, s48, v92
    v_dot2c_f32_bf16 v106, v92, v92
    v_dot2c_f32_bf16 v105, s48, v100
    v_dot2c_f32_bf16 v107, v100, v100
    v_dot2c_f32_bf16 v104, s48, v93
    v_dot2c_f32_bf16 v106, v93, v93
    v_dot2c_f32_bf16 v105, s48, v101
    v_dot2c_f32_bf16 v107, v101, v101
    v_dot2c_f32_bf16 v104, s48, v94
    v_dot2c_f32_bf16 v106, v94, v94
    v_dot2c_f32_bf16 v105, s48, v102
    v_dot2c_f32_bf16 v107, v102, v102
    v_dot2c_f32_bf16 v104, s48, v95
    v_dot2c_f32_bf16 v106, v95, v95
    v_dot2c_f32_bf16 v105, s48, v103
    v_dot2c_f32_bf16 v107, v103, v103
    s_nop 2
    v_add_f32_dpp v104, v104, v104 quad_perm:[1,0,3,2] row_mask:0xf bank_mask:0xf
    v_add_f32_dpp v105, v105, v105 quad_perm:[1,0,3,2] row_mask:0xf bank_mask:0xf
    v_add_f32_dpp v106, v106, v106 quad_perm:[1,0,3,2] row_mask:0xf bank_mask:0xf
    v_add_f32_dpp v107, v107, v107 quad_perm:[1,0,3,2] row_mask:0xf bank_mask:0xf
    v_add_f32_dpp v104, v104, v104 quad_perm:[2,3,0,1] row_mask:0xf bank_mask:0xf
    v_add_f32_dpp v105, v105, v105 quad_perm:[2,3,0,1] row_mask:0xf bank_mask:0xf
    v_add_f32_dpp v106, v106, v106 quad_perm:[2,3,0,1] row_mask:0xf bank_mask:0xf
    v_add_f32_dpp v107, v107, v107 quad_perm:[2,3,0,1] row_mask:0xf bank_mask:0xf
    v_add_f32_dpp v104, v104, v104 row_half_mirror row_mask:0xf bank_mask:0xf
    v_add_f32_dpp v105, v105, v105 row_half_mirror row_mask:0xf bank_mask:0xf
    v_add_f32_dpp v106, v106, v106 row_half_mirror row_mask:0xf bank_mask:0xf
    v_add_f32_dpp v107, v107, v107 row_half_mirror row_mask:0xf bank_mask:0xf
    v_add_f32_dpp v104, v104, v104 row_mirror row_mask:0xf bank_mask:0xf
    v_add_f32_dpp v105, v105, v105 row_mirror row_mask:0xf bank_mask:0xf
    v_add_f32_dpp v106, v106, v106 row_mirror row_mask:0xf bank_mask:0xf
    v_add_f32_dpp v107, v107, v107 row_mirror row_mask:0xf bank_mask:0xf
    v_add_f32_dpp v104, v104, v104 row_bcast:15 row_mask:0xa bank_mask:0xf
    v_add_f32_dpp v105, v105, v105 row_bcast:15 row_mask:0xa bank_mask:0xf
    v_add_f32_dpp v106, v106, v106 row_bcast:15 row_mask:0xa bank_mask:0xf
    v_add_f32_dpp v107, v107, v107 row_bcast:15 row_mask:0xa bank_mask:0xf
    v_add_f32_dpp v104, v104, v104 row_bcast:31 row_mask:0xc bank_mask:0xf
    v_add_f32_dpp v105, v105, v105 row_bcast:31 row_mask:0xc bank_mask:0xf
    v_add_f32_dpp v106, v106, v106 row_bcast:31 row_mask:0xc bank_mask:0xf
    v_add_f32_dpp v107, v107, v107 row_bcast:31 row_mask:0xc bank_mask:0xf
    v_mul_f32 v108, 0x3a800000, v104
    v_mul_f32 v109, 0x3a800000, v105
    v_mul_f32 v112, 0x3a800000, v106
    v_mul_f32 v113, 0x3a800000, v107
    v_fma_f32 v112, -v108, v108, v112
    v_fma_f32 v113, -v109, v109, v113
    v_max_f32 v112, 0, v112
    v_max_f32 v113, 0, v113
    v_cvt_pk_bf16_f32 v108, v108, v108
    v_and_b32 v108, 0xffff0000, v108
    v_cvt_pk_bf16_f32 v109, v109, v109
    v_and_b32 v109, 0xffff0000, v109
    v_cvt_pk_bf16_f32 v112, v112, v112
    v_and_b32 v112, 0xffff0000, v112
    v_cvt_pk_bf16_f32 v113, v113, v113
    v_and_b32 v113, 0xffff0000, v113
    v_add_f32 v112, 0x3727c5ac, v112
    v_add_f32 v113, 0x3727c5ac, v113
    v_cvt_pk_bf16_f32 v112, v112, v112
    v_and_b32 v112, 0xffff0000, v112
    v_cvt_pk_bf16_f32 v113, v113, v113
    v_and_b32 v113, 0xffff0000, v113
    v_sqrt_f32 v112, v112
    v_sqrt_f32 v113, v113
    s_nop 0
    v_cvt_pk_bf16_f32 v112, v112, v112
    v_and_b32 v112, 0xffff0000, v112
    v_cvt_pk_bf16_f32 v113, v113, v113
    v_and_b32 v113, 0xffff0000, v113
    s_mov_b32 s3, 0
Lsequen_f_tagB:
    v_cmp_eq_u32 vcc, 0, v204
    s_cbranch_vccz Lsequen_f_tagB_x
    buffer_load_dwordx2 v[204:205], v207, s[44:47], 0 offen sc1
    s_waitcnt vmcnt(0)
    s_add_u32 s3, s3, 1
    s_cmp_lt_u32 s3, 0x100000
    s_cbranch_scc1 Lsequen_f_tagB
Lsequen_f_tagB_x:
    v_readfirstlane_b32 s98, v204
    v_readfirstlane_b32 s99, v205
    s_mov_b32 s48, 0x07060302
    v_perm_b32 v202, v112, v108, s48
    v_perm_b32 v203, v113, v109, s48
    s_lshl_b32 s48, s2, 6
    s_lshl_b32 s49, s62, 4
    s_add_u32 s48, s48, s49
    s_add_u32 s48, s48, 0xf00000
    s_mov_b32 exec_lo, 0
    s_mov_b32 exec_hi, 0x80000000
    buffer_store_dwordx4 v[202:205], v207, s[32:35], s48 offen sc1
    s_mov_b64 exec, -1
    s_cmp_eq_u32 s62, 3
    s_cbranch_scc0 Lsequen_f_notB3
    v_and_b32 v121, 31, v0
    v_lshlrev_b32 v121, 14, v121
    s_add_u32 s28, s39, 0xd00000
    s_add_u32 s29, s39, 0xd00080
    s_mov_b32 s3, 0
    v_mov_b32 v122, 0
    s_mov_b64 exec, 0xffffffff
Lsequen_f_pollU:
    buffer_load_dwordx3 v[116:118], v121, s[32:35], s28 offen sc1
    s_add_u32 s3, s3, 1
    s_and_b32 s26, s3, 3
    s_cbranch_scc1 Lsequen_f_pollU_a
    buffer_load_dwordx3 v[122:124], v121, s[32:35], s29 offen sc1
Lsequen_f_pollU_a:
    s_cmp_gt_u32 s3, 0x100000
    s_cbranch_scc1 Lsequen_f_pollU_x
    s_waitcnt vmcnt(0)
    v_cmp_ne_u64 vcc, v[116:117], v[204:205]
    v_cmp_ne_u64 s[24:25], v[122:123], v[204:205]
    s_nop 0
    v_cndmask_b32 v118, v118, v124, vcc
    s_and_b64 vcc, vcc, s[24:25]
    s_cbranch_vccnz Lsequen_f_pollU
Lsequen_f_pollU_x:
    s_waitcnt vmcnt(0)
    v_cmp_ne_u32 vcc, s38, v118
    s_mov_b64 exec, -1
    s_cbranch_vccz Lsequen_f_oneXCD
    v_mov_b32 v200, 153724
    v_mov_b32 v201, 1
    ds_write_b32 v200, v201
    v_mov_b32 v33, 153668
Lsequen_f_waitX:
    ds_read_b32 v34, v33
    s_waitcnt lgkmcnt(0)
    v_cmp_gt_u32 vcc, 4, v34
    s_cbranch_vccnz Lsequen_f_waitX
    buffer_wbl2 sc1
    s_waitcnt vmcnt(0)
    s_lshl_b32 s3, s40, 14
    v_mov_b32 v200, s3
    s_add_u32 s3, s39, 0xd00200
    s_mov_b64 exec, 1
    buffer_store_dwordx3 v[204:206], v200, s[32:35], s3 offen sc1
    s_mov_b64 exec, -1
    v_and_b32 v121, 31, v0
    v_lshlrev_b32 v121, 14, v121
    s_add_u32 s28, s39, 0xd00200
    s_add_u32 s29, s39, 0xd00280
    s_mov_b32 s3, 0
    v_mov_b32 v122, 0
    s_mov_b64 exec, 0xffffffff
Lsequen_f_poll2:
    buffer_load_dwordx3 v[116:118], v121, s[32:35], s28 offen sc1
    s_add_u32 s3, s3, 1
    s_cmp_gt_u32 s3, 0x100000
    s_cbranch_scc1 Lsequen_f_poll2_x
    s_waitcnt vmcnt(0)
    v_cmp_ne_u64 vcc, v[116:117], v[204:205]
    s_cbranch_vccnz Lsequen_f_poll2
Lsequen_f_poll2_x:
    s_waitcnt vmcnt(0)
    v_cmp_ne_u32 vcc, s38, v118
    s_mov_b64 exec, -1
    buffer_inv sc1
    s_waitcnt vmcnt(0)
Lsequen_f_oneXCD:
    v_mov_b32 v200, 153672
    v_mov_b32 v201, 1
    ds_write_b32 v200, v201
Lsequen_f_notB3:
    v_mov_b32 v33, 153672
Lsequen_f_waitGo:
    ds_read_b32 v34, v33
    s_waitcnt lgkmcnt(0)
    v_cmp_eq_u32 vcc, 0, v34
    s_cbranch_vccnz Lsequen_f_waitGo
    s_add_u32 m0, s63, 17152
    s_add_u32 s14, s42, 0x0
    buffer_load_dwordx4 v2, s[32:35], s14 offen offset:0 nt lds
    buffer_load_dwordx4 v2, s[32:35], s14 offen offset:1024 nt lds
    buffer_load_dwordx4 v2, s[32:35], s14 offen offset:2048 nt lds
    buffer_load_dwordx4 v2, s[32:35], s14 offen offset:3072 nt lds
    s_lshl_b32 s3, s62, 2
    s_add_u32 s3, s3, 153696
    v_mov_b32 v33, s3
    v_mov_b32 v34, 2
    s_waitcnt vmcnt(0)
    ds_write_b32 v33, v34
    s_cmp_eq_u32 s62, 1
    s_cbranch_scc0 Lsequen_f_notB1
    s_lshl_b32 s3, s2, 11
    s_add_u32 s3, s3, 0xd00380
    s_mov_b64 exec, 1
    buffer_store_dwordx3 v[204:206], v207, s[32:35], s3 offen sc1
    s_mov_b64 exec, -1
Lsequen_f_notB1:
    s_cmp_ge_u32 s62, 2
    s_cbranch_scc1 Lsequen_f_bfetch
    s_mov_b64 exec, -1
    v_mov_b32 v200, 153716
    v_mov_b32 v201, 1
    s_waitcnt vmcnt(0)
    s_mov_b64 exec, 1
    ds_add_rtn_u32 v202, v200, v201
    s_waitcnt lgkmcnt(0)
    v_readfirstlane_b32 s3, v202
    s_cmp_eq_u32 s3, 7
    s_cbranch_scc0 Lsequen_f_finB01
    s_lshl_b32 s3, s2, 11
    s_add_u32 s3, s3, 0xd00280
    buffer_store_dwordx2 v[204:205], v207, s[32:35], s3 offen sc1
Lsequen_f_finB01:
    s_mov_b64 exec, -1
    v_mov_b32 v33, 153720
Lsequen_f_waitG:
    s_sleep 2
    ds_read_b32 v34, v33
    s_waitcnt lgkmcnt(0)
    v_cmp_gt_u32 vcc, 2, v34
    s_cbranch_vccnz Lsequen_f_waitG
    s_branch Lmlp_loader
Lsequen_f_bfetch:
    s_sub_u32 s11, s62, 2
    s_lshl_b32 s12, s11, 13
    v_and_b32 v121, 31, v0
    v_lshlrev_b32 v121, 14, v121
    s_add_u32 s28, s39, 0xd00100
    s_add_u32 s29, s39, 0xd00180
    s_mov_b32 s3, 0
    v_mov_b32 v122, 0
    s_mov_b64 exec, 0xffffffff
Lsequen_f_pollX:
    buffer_load_dwordx3 v[116:118], v121, s[32:35], s28 offen sc1
    s_add_u32 s3, s3, 1
    s_and_b32 s26, s3, 3
    s_cbranch_scc1 Lsequen_f_pollX_a
    buffer_load_dwordx3 v[122:124], v121, s[32:35], s29 offen sc1
Lsequen_f_pollX_a:
    s_cmp_gt_u32 s3, 0x100000
    s_cbranch_scc1 Lsequen_f_pollX_x
    s_waitcnt vmcnt(0)
    v_cmp_ne_u64 vcc, v[116:117], v[204:205]
    v_cmp_ne_u64 s[24:25], v[122:123], v[204:205]
    s_nop 0
    v_cndmask_b32 v118, v118, v124, vcc
    s_and_b64 vcc, vcc, s[24:25]
    s_cbranch_vccnz Lsequen_f_pollX
Lsequen_f_pollX_x:
    s_waitcnt vmcnt(0)
    v_cmp_ne_u32 vcc, s38, v118
    s_mov_b64 exec, -1
    s_sub_u32 s13, s61, s62
    s_lshl_b32 s13, s13, 12
    s_add_u32 s13, s13, s12
    s_add_u32 m0, s12, 90112
    s_add_u32 s14, s13, 0x400000
    buffer_load_dwordx4 v2, s[32:35], s14 offen offset:0 nt lds
    buffer_load_dwordx4 v2, s[32:35], s14 offen offset:1024 nt lds
    buffer_load_dwordx4 v2, s[32:35], s14 offen offset:2048 nt lds
    buffer_load_dwordx4 v2, s[32:35], s14 offen offset:3072 nt lds
    s_add_u32 m0, s12, 94208
    s_add_u32 s14, s13, 0x401000
    buffer_load_dwordx4 v2, s[32:35], s14 offen offset:0 nt lds
    buffer_load_dwordx4 v2, s[32:35], s14 offen offset:1024 nt lds
    buffer_load_dwordx4 v2, s[32:35], s14 offen offset:2048 nt lds
    buffer_load_dwordx4 v2, s[32:35], s14 offen offset:3072 nt lds
    s_add_u32 s13, s12, 0xf00000
    s_add_u32 s14, s13, 4096
    s_mov_b32 s3, 0
    buffer_load_dwordx4 v[16:19], v2, s[32:35], s13 offen offset:0
    buffer_load_dwordx4 v[20:23], v2, s[32:35], s13 offen offset:1024
    buffer_load_dwordx4 v[24:27], v2, s[32:35], s13 offen offset:2048
    buffer_load_dwordx4 v[28:31], v2, s[32:35], s13 offen offset:3072
    buffer_load_dwordx4 v[32:35], v2, s[32:35], s14 offen offset:0
    buffer_load_dwordx4 v[36:39], v2, s[32:35], s14 offen offset:1024
    buffer_load_dwordx4 v[40:43], v2, s[32:35], s14 offen offset:2048
    buffer_load_dwordx4 v[44:47], v2, s[32:35], s14 offen offset:3072
    v_mov_b32 v200, 153720
    v_mov_b32 v201, 1
    s_mov_b64 exec, 1
    ds_add_u32 v200, v201
    s_mov_b64 exec, -1
    s_branch Lsequen_f_pollS_c
Lsequen_f_pollS:
    buffer_load_dwordx4 v[16:19], v2, s[32:35], s13 offen offset:0 sc1
    buffer_load_dwordx4 v[20:23], v2, s[32:35], s13 offen offset:1024 sc1
    buffer_load_dwordx4 v[24:27], v2, s[32:35], s13 offen offset:2048 sc1
    buffer_load_dwordx4 v[28:31], v2, s[32:35], s13 offen offset:3072 sc1
    buffer_load_dwordx4 v[32:35], v2, s[32:35], s14 offen offset:0 sc1
    buffer_load_dwordx4 v[36:39], v2, s[32:35], s14 offen offset:1024 sc1
    buffer_load_dwordx4 v[40:43], v2, s[32:35], s14 offen offset:2048 sc1
    buffer_load_dwordx4 v[44:47], v2, s[32:35], s14 offen offset:3072 sc1
Lsequen_f_pollS_c:
    s_add_u32 s3, s3, 1
    s_cmp_gt_u32 s3, 0x40000
    s_cbranch_scc1 Lsequen_f_pollS_x
    s_waitcnt vmcnt(0)
    s_mov_b64 s[22:23], 0
    v_cmp_ne_u64 vcc, v[18:19], v[204:205]
    s_or_b64 s[22:23], s[22:23], vcc
    v_cmp_ne_u64 vcc, v[22:23], v[204:205]
    s_or_b64 s[22:23], s[22:23], vcc
    v_cmp_ne_u64 vcc, v[26:27], v[204:205]
    s_or_b64 s[22:23], s[22:23], vcc
    v_cmp_ne_u64 vcc, v[30:31], v[204:205]
    s_or_b64 s[22:23], s[22:23], vcc
    v_cmp_ne_u64 vcc, v[34:35], v[204:205]
    s_or_b64 s[22:23], s[22:23], vcc
    v_cmp_ne_u64 vcc, v[38:39], v[204:205]
    s_or_b64 s[22:23], s[22:23], vcc
    v_cmp_ne_u64 vcc, v[42:43], v[204:205]
    s_or_b64 s[22:23], s[22:23], vcc
    v_cmp_ne_u64 vcc, v[46:47], v[204:205]
    s_or_b64 s[22:23], s[22:23], vcc
    s_cmp_lg_u64 s[22:23], 0
    s_cbranch_scc0 Lsequen_f_pollS_x
    s_sleep 8
    s_branch Lsequen_f_pollS
Lsequen_f_pollS_x:
    s_waitcnt vmcnt(0)
    s_lshl_b32 s13, s11, 12
    s_add_u32 s13, s13, 135168
    v_lshl_add_u32 v3, v0, 3, s13
    s_mov_b32 s14, 0xffff0000
    v_and_b32 v18, s14, v16
    v_and_b32 v19, s14, v17
    v_lshlrev_b32 v16, 16, v16
    v_lshlrev_b32 v17, 16, v17
    v_rcp_f32 v18, v18
    v_rcp_f32 v19, v19
    ds_write_b64 v3, v[16:17] offset:0
    ds_write_b64 v3, v[18:19] offset:8192
    v_and_b32 v22, s14, v20
    v_and_b32 v23, s14, v21
    v_lshlrev_b32 v20, 16, v20
    v_lshlrev_b32 v21, 16, v21
    v_rcp_f32 v22, v22
    v_rcp_f32 v23, v23
    ds_write_b64 v3, v[20:21] offset:512
    ds_write_b64 v3, v[22:23] offset:8704
    v_and_b32 v26, s14, v24
    v_and_b32 v27, s14, v25
    v_lshlrev_b32 v24, 16, v24
    v_lshlrev_b32 v25, 16, v25
    v_rcp_f32 v26, v26
    v_rcp_f32 v27, v27
    ds_write_b64 v3, v[24:25] offset:1024
    ds_write_b64 v3, v[26:27] offset:9216
    v_and_b32 v30, s14, v28
    v_and_b32 v31, s14, v29
    v_lshlrev_b32 v28, 16, v28
    v_lshlrev_b32 v29, 16, v29
    v_rcp_f32 v30, v30
    v_rcp_f32 v31, v31
    ds_write_b64 v3, v[28:29] offset:1536
    ds_write_b64 v3, v[30:31] offset:9728
    v_and_b32 v34, s14, v32
    v_and_b32 v35, s14, v33
    v_lshlrev_b32 v32, 16, v32
    v_lshlrev_b32 v33, 16, v33
    v_rcp_f32 v34, v34
    v_rcp_f32 v35, v35
    ds_write_b64 v3, v[32:33] offset:2048
    ds_write_b64 v3, v[34:35] offset:10240
    v_and_b32 v38, s14, v36
    v_and_b32 v39, s14, v37
    v_lshlrev_b32 v36, 16, v36
    v_lshlrev_b32 v37, 16, v37
    v_rcp_f32 v38, v38
    v_rcp_f32 v39, v39
    ds_write_b64 v3, v[36:37] offset:2560
    ds_write_b64 v3, v[38:39] offset:10752
    v_and_b32 v42, s14, v40
    v_and_b32 v43, s14, v41
    v_lshlrev_b32 v40, 16, v40
    v_lshlrev_b32 v41, 16, v41
    v_rcp_f32 v42, v42
    v_rcp_f32 v43, v43
    ds_write_b64 v3, v[40:41] offset:3072
    ds_write_b64 v3, v[42:43] offset:11264
    v_and_b32 v46, s14, v44
    v_and_b32 v47, s14, v45
    v_lshlrev_b32 v44, 16, v44
    v_lshlrev_b32 v45, 16, v45
    v_rcp_f32 v46, v46
    v_rcp_f32 v47, v47
    ds_write_b64 v3, v[44:45] offset:3584
    ds_write_b64 v3, v[46:47] offset:11776
    s_lshl_b32 s12, s11, 2
    s_add_u32 s12, s12, 153680
    v_mov_b32 v4, s12
    v_mov_b32 v5, 1
    s_waitcnt vmcnt(0) lgkmcnt(0)
    ds_write_b32 v4, v5
Lsequen_f_bdone:
    s_mov_b64 exec, -1
    v_mov_b32 v200, 153716
    v_mov_b32 v201, 1
    s_waitcnt vmcnt(0)
    s_mov_b64 exec, 1
    ds_add_rtn_u32 v202, v200, v201
    s_waitcnt lgkmcnt(0)
    v_readfirstlane_b32 s3, v202
    s_cmp_eq_u32 s3, 7
    s_cbranch_scc0 Lsequen_f_finB
    s_lshl_b32 s3, s2, 11
    s_add_u32 s3, s3, 0xd00280
    buffer_store_dwordx2 v[204:205], v207, s[32:35], s3 offen sc1
Lsequen_f_finB:
    s_mov_b64 exec, -1
    s_branch Lmlp_loader
Lsequen_f_end:
    s_endpgm
Lmlp_compute:
    s_load_dwordx4 s[4:7], s[0:1], 56
    s_load_dwordx2 s[8:9], s[0:1], 88
    s_load_dwordx2 s[56:57], s[0:1], 72
    s_mov_b32 s10, s60
    s_mov_b32 s55, s38
    s_and_b32 s11, s2, 7
    s_lshr_b32 s12, s2, 3
    s_lshr_b32 s13, s11, 1
    s_lshl_b32 s13, s13, 2
    s_and_b32 s14, s12, 3
    s_add_u32 s13, s13, s14
    s_and_b32 s15, s11, 1
    s_lshr_b32 s53, s12, 2
    s_lshl_b32 s14, s15, 3
    s_add_u32 s14, s14, s53
    v_lshrrev_b32 v2, 4, v0
    v_bfe_u32 v3, v0, 2, 2
    v_and_b32 v4, 3, v0
    v_and_b32 v5, 1, v2
    v_lshl_or_b32 v6, v5, 2, v3
    v_lshl_add_u32 v7, v2, 3, v3
    v_lshlrev_b32 v8, 8, v7
    v_lshl_add_u32 v8, v4, 3, v8
    s_and_b32 s24, s10, 1
    s_lshr_b32 s25, s10, 1
    v_mul_u32_u24 v12, 448, v7
    v_lshl_add_u32 v12, v4, 3, v12
    v_add_u32 v12, 106496, v12
    v_add_u32 v8, 90112, v8
    v_lshl_add_u32 v13, v5, 5, v12
    v_xor_b32 v14, 1, v5
    v_lshl_add_u32 v14, v14, 5, v12
    s_lshl_b32 s26, s25, 8
    v_add_u32 v9, s26, v13
    v_add_u32 v10, s26, v14
    s_cmp_eq_u32 s25, 0
    s_cselect_b64 vcc, -1, 0
    v_cndmask_b32 v11, v14, v13, vcc
    v_add_u32 v11, 192, v11
    v_mov_b32 v15, v2
    s_lshl_b32 s26, s24, 2
    s_add_u32 s27, s26, 0
    v_xor_b32 v12, s27, v6
    v_lshl_add_u32 v1, v12, 5, v8
    s_add_u32 s27, s26, 1
    v_xor_b32 v12, s27, v6
    v_lshl_add_u32 v2, v12, 5, v8
    s_add_u32 s27, s26, 2
    v_xor_b32 v12, s27, v6
    v_lshl_add_u32 v3, v12, 5, v8
    s_add_u32 s27, s26, 3
    v_xor_b32 v12, s27, v6
    v_lshl_add_u32 v4, v12, 5, v8
    v_mov_b32 v16, 0
    v_mov_b32 v17, 0
    v_mov_b32 v18, 0
    v_mov_b32 v19, 0
    v_mov_b32 v20, 0
    v_mov_b32 v21, 0
    v_mov_b32 v22, 0
    v_mov_b32 v23, 0
    v_mov_b32 v24, 0
    v_mov_b32 v25, 0
    v_mov_b32 v26, 0
    v_mov_b32 v27, 0
    v_mov_b32 v28, 0
    v_mov_b32 v29, 0
    v_mov_b32 v30, 0
    v_mov_b32 v31, 0
    v_mov_b32 v32, 0
    v_mov_b32 v33, 0
    v_mov_b32 v34, 0
    v_mov_b32 v35, 0
    v_mov_b32 v36, 0
    v_mov_b32 v37, 0
    v_mov_b32 v38, 0
    v_mov_b32 v39, 0
    v_mov_b32 v40, 0
    v_mov_b32 v41, 0
    v_mov_b32 v42, 0
    v_mov_b32 v43, 0
    v_mov_b32 v44, 0
    v_mov_b32 v45, 0
    v_mov_b32 v46, 0
    v_mov_b32 v47, 0
    v_mov_b32 v48, 0
    v_mov_b32 v49, 0
    v_mov_b32 v50, 0
    v_mov_b32 v51, 0
    v_mov_b32 v52, 0
    v_mov_b32 v53, 0
    v_mov_b32 v54, 0
    v_mov_b32 v55, 0
    v_mov_b32 v56, 0
    v_mov_b32 v57, 0
    v_mov_b32 v58, 0
    v_mov_b32 v59, 0
    v_mov_b32 v60, 0
    v_mov_b32 v61, 0
    v_mov_b32 v62, 0
    v_mov_b32 v63, 0
    v_mov_b32 v64, 0
    v_mov_b32 v65, 0
    v_mov_b32 v66, 0
    v_mov_b32 v67, 0
    v_mov_b32 v68, 0
    v_mov_b32 v69, 0
    v_mov_b32 v70, 0
    v_mov_b32 v71, 0
    v_mov_b32 v72, 0
    v_mov_b32 v73, 0
    v_mov_b32 v74, 0
    v_mov_b32 v75, 0
    v_mov_b32 v76, 0
    v_mov_b32 v77, 0
    v_mov_b32 v78, 0
    v_mov_b32 v79, 0
    v_mov_b32 v80, 0
    v_mov_b32 v81, 0
    v_mov_b32 v82, 0
    v_mov_b32 v83, 0
    v_mov_b32 v84, 0
    v_mov_b32 v85, 0
    v_mov_b32 v86, 0
    v_mov_b32 v87, 0
    v_mov_b32 v88, 0
    v_mov_b32 v89, 0
    v_mov_b32 v90, 0
    v_mov_b32 v91, 0
    v_mov_b32 v92, 0
    v_mov_b32 v93, 0
    v_mov_b32 v94, 0
    v_mov_b32 v95, 0
    v_mov_b32 v96, 0
    v_mov_b32 v97, 0
    v_mov_b32 v98, 0
    v_mov_b32 v99, 0
    v_mov_b32 v100, 0
    v_mov_b32 v101, 0
    v_mov_b32 v102, 0
    v_mov_b32 v103, 0
    v_mov_b32 v104, 0
    v_mov_b32 v105, 0
    v_mov_b32 v106, 0
    v_mov_b32 v107, 0
    v_mov_b32 v108, 0
    v_mov_b32 v109, 0
    v_mov_b32 v110, 0
    v_mov_b32 v111, 0
    v_mov_b32 v112, 0
    v_mov_b32 v113, 0
    v_mov_b32 v114, 0
    v_mov_b32 v115, 0
    v_mov_b32 v116, 0
    v_mov_b32 v117, 0
    v_mov_b32 v118, 0
    v_mov_b32 v119, 0
    v_mov_b32 v120, 0
    v_mov_b32 v121, 0
    v_mov_b32 v122, 0
    v_mov_b32 v123, 0
    v_mov_b32 v124, 0
    v_mov_b32 v125, 0
    v_mov_b32 v126, 0
    v_mov_b32 v127, 0
    v_mov_b32 v12, 153724
    ds_read_b32 v12, v12
    s_waitcnt lgkmcnt(0)
    v_readfirstlane_b32 s74, v12
    s_cmp_eq_u32 s74, 0
    s_cselect_b32 s74, 2, 0
    s_mov_b32 s20, s8
    s_and_b32 s21, s9, 0xffff
    s_mov_b32 s22, 0x10000000
    s_mov_b32 s23, 0x20000
    s_mov_b32 s44, s56
    s_and_b32 s45, s57, 0xffff
    s_mov_b32 s46, 0x400000
    s_mov_b32 s47, 0x20000
    s_mov_b32 s28, 0
    s_mov_b32 s29, 2
    s_barrier
    ds_read_b64_tr_b16 v[156:157], v1 offset:0
    ds_read_b64_tr_b16 v[158:159], v1 offset:1024
    ds_read_b64_tr_b16 v[160:161], v2 offset:0
    ds_read_b64_tr_b16 v[162:163], v2 offset:1024
    ds_read_b64_tr_b16 v[164:165], v3 offset:0
    ds_read_b64_tr_b16 v[166:167], v3 offset:1024
    ds_read_b64_tr_b16 v[168:169], v4 offset:0
    ds_read_b64_tr_b16 v[170:171], v4 offset:1024
    ds_read_b64_tr_b16 v[128:129], v9 offset:0
    ds_read_b64_tr_b16 v[130:131], v9 offset:1792
    ds_read_b64_tr_b16 v[132:133], v10 offset:0
    ds_read_b64_tr_b16 v[134:135], v10 offset:1792
    ds_read_b64_tr_b16 v[136:137], v9 offset:64
    ds_read_b64_tr_b16 v[138:139], v9 offset:1856
    ds_read_b64_tr_b16 v[140:141], v10 offset:64
    ds_read_b64_tr_b16 v[142:143], v10 offset:1856
    ds_read_b64_tr_b16 v[144:145], v9 offset:128
    ds_read_b64_tr_b16 v[146:147], v9 offset:1920
    ds_read_b64_tr_b16 v[148:149], v10 offset:128
    ds_read_b64_tr_b16 v[150:151], v10 offset:1920
    ds_read_b64_tr_b16 v[152:153], v11 offset:0
    ds_read_b64_tr_b16 v[154:155], v11 offset:1792
Lsequen_m_c1loop:
    s_waitcnt lgkmcnt(12)
    v_mfma_f32_16x16x32_bf16 v[16:19], v[128:131], v[156:159], v[16:19]
    ds_read_b64_tr_b16 v[200:201], v1 offset:8192
    v_mfma_f32_16x16x32_bf16 v[20:23], v[128:131], v[160:163], v[20:23]
    ds_read_b64_tr_b16 v[202:203], v1 offset:9216
    v_mfma_f32_16x16x32_bf16 v[24:27], v[128:131], v[164:167], v[24:27]
    ds_read_b64_tr_b16 v[204:205], v2 offset:8192
    v_mfma_f32_16x16x32_bf16 v[28:31], v[128:131], v[168:171], v[28:31]
    ds_read_b64_tr_b16 v[206:207], v2 offset:9216
    s_waitcnt lgkmcnt(14)
    v_mfma_f32_16x16x32_bf16 v[32:35], v[132:135], v[156:159], v[32:35]
    ds_read_b64_tr_b16 v[208:209], v3 offset:8192
    v_mfma_f32_16x16x32_bf16 v[36:39], v[132:135], v[160:163], v[36:39]
    ds_read_b64_tr_b16 v[210:211], v3 offset:9216
    v_mfma_f32_16x16x32_bf16 v[40:43], v[132:135], v[164:167], v[40:43]
    ds_read_b64_tr_b16 v[212:213], v4 offset:8192
    v_mfma_f32_16x16x32_bf16 v[44:47], v[132:135], v[168:171], v[44:47]
    ds_read_b64_tr_b16 v[214:215], v4 offset:9216
    s_waitcnt lgkmcnt(15)
    v_mfma_f32_16x16x32_bf16 v[48:51], v[136:139], v[156:159], v[48:51]
    ds_read_b64_tr_b16 v[172:173], v9 offset:14336
    v_mfma_f32_16x16x32_bf16 v[52:55], v[136:139], v[160:163], v[52:55]
    ds_read_b64_tr_b16 v[174:175], v9 offset:16128
    v_mfma_f32_16x16x32_bf16 v[56:59], v[136:139], v[164:167], v[56:59]
    ds_read_b64_tr_b16 v[176:177], v10 offset:14336
    v_mfma_f32_16x16x32_bf16 v[60:63], v[136:139], v[168:171], v[60:63]
    ds_read_b64_tr_b16 v[178:179], v10 offset:16128
    s_waitcnt lgkmcnt(15)
    v_mfma_f32_16x16x32_bf16 v[64:67], v[140:143], v[156:159], v[64:67]
    ds_read_b64_tr_b16 v[180:181], v9 offset:14400
    v_mfma_f32_16x16x32_bf16 v[68:71], v[140:143], v[160:163], v[68:71]
    ds_read_b64_tr_b16 v[182:183], v9 offset:16192
    v_mfma_f32_16x16x32_bf16 v[72:75], v[140:143], v[164:167], v[72:75]
    ds_read_b64_tr_b16 v[184:185], v10 offset:14400
    v_mfma_f32_16x16x32_bf16 v[76:79], v[140:143], v[168:171], v[76:79]
    ds_read_b64_tr_b16 v[186:187], v10 offset:16192
    s_waitcnt lgkmcnt(15)
    v_mfma_f32_16x16x32_bf16 v[80:83], v[144:147], v[156:159], v[80:83]
    ds_read_b64_tr_b16 v[188:189], v9 offset:14464
    v_mfma_f32_16x16x32_bf16 v[84:87], v[144:147], v[160:163], v[84:87]
    ds_read_b64_tr_b16 v[190:191], v9 offset:16256
    v_mfma_f32_16x16x32_bf16 v[88:91], v[144:147], v[164:167], v[88:91]
    ds_read_b64_tr_b16 v[192:193], v10 offset:14464
    v_mfma_f32_16x16x32_bf16 v[92:95], v[144:147], v[168:171], v[92:95]
    ds_read_b64_tr_b16 v[194:195], v10 offset:16256
    s_waitcnt lgkmcnt(15)
    v_mfma_f32_16x16x32_bf16 v[96:99], v[148:151], v[156:159], v[96:99]
    ds_read_b64_tr_b16 v[196:197], v11 offset:14336
    v_mfma_f32_16x16x32_bf16 v[100:103], v[148:151], v[160:163], v[100:103]
    ds_read_b64_tr_b16 v[198:199], v11 offset:16128
    v_mfma_f32_16x16x32_bf16 v[104:107], v[148:151], v[164:167], v[104:107]
    s_add_u32 s29, s29, 1
    v_mfma_f32_16x16x32_bf16 v[108:111], v[148:151], v[168:171], v[108:111]
    s_mov_b32 s30, 45056
    s_waitcnt lgkmcnt(15)
    v_mfma_f32_16x16x32_bf16 v[112:115], v[152:155], v[156:159], v[112:115]
    s_cmp_eq_u32 s29, 3
    v_mfma_f32_16x16x32_bf16 v[116:119], v[152:155], v[160:163], v[116:119]
    s_cselect_b32 s30, -90112, s30
    v_mfma_f32_16x16x32_bf16 v[120:123], v[152:155], v[164:167], v[120:123]
    s_cselect_b32 s29, 0, s29
    v_mfma_f32_16x16x32_bf16 v[124:127], v[152:155], v[168:171], v[124:127]
    s_add_u32 s28, s28, 1
    s_waitcnt lgkmcnt(12)
    v_mfma_f32_16x16x32_bf16 v[16:19], v[172:175], v[200:203], v[16:19]
    v_mfma_f32_16x16x32_bf16 v[20:23], v[172:175], v[204:207], v[20:23]
    v_mfma_f32_16x16x32_bf16 v[24:27], v[172:175], v[208:211], v[24:27]
    v_mfma_f32_16x16x32_bf16 v[28:31], v[172:175], v[212:215], v[28:31]
    s_waitcnt lgkmcnt(0)
    s_barrier
    v_mfma_f32_16x16x32_bf16 v[32:35], v[176:179], v[200:203], v[32:35]
    v_add_u32 v1, s30, v1
    v_add_u32 v2, s30, v2
    v_mfma_f32_16x16x32_bf16 v[36:39], v[176:179], v[204:207], v[36:39]
    v_add_u32 v3, s30, v3
    v_add_u32 v4, s30, v4
    v_mfma_f32_16x16x32_bf16 v[40:43], v[176:179], v[208:211], v[40:43]
    v_add_u32 v9, s30, v9
    v_add_u32 v10, s30, v10
    v_mfma_f32_16x16x32_bf16 v[44:47], v[176:179], v[212:215], v[44:47]
    v_add_u32 v11, s30, v11
    ds_read_b64_tr_b16 v[156:157], v1 offset:0
    v_mfma_f32_16x16x32_bf16 v[48:51], v[180:183], v[200:203], v[48:51]
    ds_read_b64_tr_b16 v[158:159], v1 offset:1024
    ds_read_b64_tr_b16 v[160:161], v2 offset:0
    v_mfma_f32_16x16x32_bf16 v[52:55], v[180:183], v[204:207], v[52:55]
    ds_read_b64_tr_b16 v[162:163], v2 offset:1024
    ds_read_b64_tr_b16 v[164:165], v3 offset:0
    v_mfma_f32_16x16x32_bf16 v[56:59], v[180:183], v[208:211], v[56:59]
    ds_read_b64_tr_b16 v[166:167], v3 offset:1024
    v_mfma_f32_16x16x32_bf16 v[60:63], v[180:183], v[212:215], v[60:63]
    ds_read_b64_tr_b16 v[168:169], v4 offset:0
    v_mfma_f32_16x16x32_bf16 v[64:67], v[184:187], v[200:203], v[64:67]
    ds_read_b64_tr_b16 v[170:171], v4 offset:1024
    v_mfma_f32_16x16x32_bf16 v[68:71], v[184:187], v[204:207], v[68:71]
    ds_read_b64_tr_b16 v[128:129], v9 offset:0
    v_mfma_f32_16x16x32_bf16 v[72:75], v[184:187], v[208:211], v[72:75]
    ds_read_b64_tr_b16 v[130:131], v9 offset:1792
    v_mfma_f32_16x16x32_bf16 v[76:79], v[184:187], v[212:215], v[76:79]
    ds_read_b64_tr_b16 v[132:133], v10 offset:0
    v_mfma_f32_16x16x32_bf16 v[80:83], v[188:191], v[200:203], v[80:83]
    ds_read_b64_tr_b16 v[134:135], v10 offset:1792
    v_mfma_f32_16x16x32_bf16 v[84:87], v[188:191], v[204:207], v[84:87]
    ds_read_b64_tr_b16 v[136:137], v9 offset:64
    v_mfma_f32_16x16x32_bf16 v[88:91], v[188:191], v[208:211], v[88:91]
    ds_read_b64_tr_b16 v[138:139], v9 offset:1856
    v_mfma_f32_16x16x32_bf16 v[92:95], v[188:191], v[212:215], v[92:95]
    ds_read_b64_tr_b16 v[140:141], v10 offset:64
    v_mfma_f32_16x16x32_bf16 v[96:99], v[192:195], v[200:203], v[96:99]
    ds_read_b64_tr_b16 v[142:143], v10 offset:1856
    v_mfma_f32_16x16x32_bf16 v[100:103], v[192:195], v[204:207], v[100:103]
    ds_read_b64_tr_b16 v[144:145], v9 offset:128
    v_mfma_f32_16x16x32_bf16 v[104:107], v[192:195], v[208:211], v[104:107]
    ds_read_b64_tr_b16 v[146:147], v9 offset:1920
    v_mfma_f32_16x16x32_bf16 v[108:111], v[192:195], v[212:215], v[108:111]
    ds_read_b64_tr_b16 v[148:149], v10 offset:128
    v_mfma_f32_16x16x32_bf16 v[112:115], v[196:199], v[200:203], v[112:115]
    ds_read_b64_tr_b16 v[150:151], v10 offset:1920
    v_mfma_f32_16x16x32_bf16 v[116:119], v[196:199], v[204:207], v[116:119]
    ds_read_b64_tr_b16 v[152:153], v11 offset:0
    v_mfma_f32_16x16x32_bf16 v[120:123], v[196:199], v[208:211], v[120:123]
    ds_read_b64_tr_b16 v[154:155], v11 offset:1792
    v_mfma_f32_16x16x32_bf16 v[124:127], v[196:199], v[212:215], v[124:127]
    s_cmp_lt_u32 s28, 16
    s_cbranch_scc1 Lsequen_m_c1loop
    v_and_b32 v1, 15, v0
    s_lshl_b32 s26, s24, 9
    s_add_u32 s26, s26, 151552
    v_lshl_add_u32 v1, v1, 3, s26
    s_lshl_b32 s26, s25, 9
    s_add_u32 s26, s26, 152576
    v_lshl_add_u32 v2, v15, 4, s26
    s_mul_i32 s26, s25, 64
    s_add_u32 s26, s26, 152960
    v_lshl_add_u32 v3, v15, 4, s26
    v_mov_b32 v6, 153600
    s_waitcnt lgkmcnt(0)
    ds_read_b32 v7, v6 offset:4
    ds_read_b64 v[128:129], v1 offset:0
    ds_read_b64 v[130:131], v1 offset:128
    ds_read_b64 v[132:133], v1 offset:256
    ds_read_b64 v[134:135], v1 offset:384
    ds_read_b128 v[144:147], v2 offset:0
    ds_read_b128 v[148:151], v2 offset:64
    ds_read_b128 v[152:155], v2 offset:128
    ds_read_b128 v[156:159], v2 offset:192
    ds_read_b128 v[160:163], v2 offset:256
    ds_read_b128 v[164:167], v2 offset:320
    ds_read_b128 v[168:171], v3 offset:0
    s_lshl_b32 s26, s25, 12
    v_lshl_add_u32 v4, v0, 4, s26
    s_lshl_b32 s26, s25, 3
    s_add_u32 s26, s26, 3072
    v_lshl_add_u32 v5, v0, 4, s26
    s_lshl_b32 s26, s24, 1
    s_and_b32 s32, s12, 3
    s_lshl_b32 s60, s32, 1
    s_add_u32 s60, s60, s26
    s_lshl_b32 s32, s32, 2
    s_add_u32 s32, s32, s26
    s_lshl_b32 s61, s11, 4
    s_add_u32 s32, s32, s61
    s_mul_i32 s32, s32, 114688
    s_add_u32 s32, s32, 0x1000000
    s_and_b32 s61, s60, 3
    s_mul_i32 s61, s61, 114688
    s_lshr_b32 s60, s60, 2
    s_lshl_b32 s60, s60, 22
    s_add_u32 s60, s60, s61
    s_lshl_b32 s61, s11, 19
    s_add_u32 s60, s60, s61
    s_cmp_lt_u32 s26, s74
    s_cselect_b32 s32, s60, s32
    s_add_u32 s26, s26, 1
    s_and_b32 s34, s12, 3
    s_lshl_b32 s60, s34, 1
    s_add_u32 s60, s60, s26
    s_lshl_b32 s34, s34, 2
    s_add_u32 s34, s34, s26
    s_lshl_b32 s61, s11, 4
    s_add_u32 s34, s34, s61
    s_mul_i32 s34, s34, 114688
    s_add_u32 s34, s34, 0x1000000
    s_and_b32 s61, s60, 3
    s_mul_i32 s61, s61, 114688
    s_lshr_b32 s60, s60, 2
    s_lshl_b32 s60, s60, 22
    s_add_u32 s60, s60, s61
    s_lshl_b32 s61, s11, 19
    s_add_u32 s60, s60, s61
    s_cmp_lt_u32 s26, s74
    s_cselect_b32 s34, s60, s34
    s_mul_i32 s27, s53, 7168
    s_add_u32 s32, s32, s27
    s_add_u32 s34, s34, s27
    s_add_u32 s33, s32, 57344
    s_add_u32 s35, s34, 57344
    s_waitcnt lgkmcnt(0)
    v_readfirstlane_b32 s54, v7
    v_mul_f32 v136, 0xbfb8aa3b, v129
    v_mul_f32 v138, 0xbfb8aa3b, v131
    v_mul_f32 v140, 0xbfb8aa3b, v133
    v_mul_f32 v142, 0xbfb8aa3b, v135
    s_and_b32 s26, s53, 1
    s_lshl_b32 s27, s25, 2
    s_sub_u32 s27, s27, s26
    s_add_u32 s60, s27, 0
    s_lshr_b32 s61, s60, 1
    s_lshl_b32 s61, s61, 15
    s_and_b32 s62, s60, 1
    s_lshl_b32 s62, s62, 10
    s_add_u32 s61, s61, s62
    s_cmp_lt_u32 s60, 6
    s_cselect_b32 s61, s61, 98304
    s_lshl_b32 s62, s24, 13
    s_add_u32 s61, s61, s62
    v_lshl_add_u32 v8, v0, 4, s61
    s_add_u32 s60, s27, 1
    s_lshr_b32 s61, s60, 1
    s_lshl_b32 s61, s61, 15
    s_and_b32 s62, s60, 1
    s_lshl_b32 s62, s62, 10
    s_add_u32 s61, s61, s62
    s_cmp_lt_u32 s60, 6
    s_cselect_b32 s61, s61, 98304
    s_lshl_b32 s62, s24, 13
    s_add_u32 s61, s61, s62
    v_lshl_add_u32 v9, v0, 4, s61
    s_add_u32 s60, s27, 2
    s_lshr_b32 s61, s60, 1
    s_lshl_b32 s61, s61, 15
    s_and_b32 s62, s60, 1
    s_lshl_b32 s62, s62, 10
    s_add_u32 s61, s61, s62
    s_cmp_lt_u32 s60, 6
    s_cselect_b32 s61, s61, 98304
    s_lshl_b32 s62, s24, 13
    s_add_u32 s61, s61, s62
    v_lshl_add_u32 v10, v0, 4, s61
    s_sub_u32 s60, 3, s26
    s_lshr_b32 s61, s60, 1
    s_lshl_b32 s61, s61, 15
    s_and_b32 s62, s60, 1
    s_lshl_b32 s62, s62, 10
    s_add_u32 s61, s61, s62
    s_cmp_lt_u32 s60, 6
    s_cselect_b32 s61, s61, 98304
    s_lshl_b32 s62, s24, 13
    s_add_u32 s61, s61, s62
    s_lshl_b32 s62, s25, 3
    s_add_u32 s61, s61, s62
    v_lshl_add_u32 v11, v0, 4, s61
    s_mov_b32 s58, 0xbfb8aa3b
    s_mov_b32 s59, 0xbfb8aa3b
    s_cmp_eq_u32 s54, 1
    v_pk_fma_f32 v[16:17], v[144:145], v[128:129], v[16:17] op_sel_hi:[1,0,1] neg_lo:[0,1,0] neg_hi:[0,1,0]
    v_pk_fma_f32 v[18:19], v[146:147], v[128:129], v[18:19] op_sel_hi:[1,0,1] neg_lo:[0,1,0] neg_hi:[0,1,0]
    v_pk_fma_f32 v[32:33], v[148:149], v[128:129], v[32:33] op_sel_hi:[1,0,1] neg_lo:[0,1,0] neg_hi:[0,1,0]
    v_pk_fma_f32 v[34:35], v[150:151], v[128:129], v[34:35] op_sel_hi:[1,0,1] neg_lo:[0,1,0] neg_hi:[0,1,0]
    v_pk_mul_f32 v[172:173], v[16:17], v[136:137] op_sel_hi:[1,0]
    v_pk_mul_f32 v[174:175], v[18:19], v[136:137] op_sel_hi:[1,0]
    v_pk_mul_f32 v[176:177], v[32:33], v[136:137] op_sel_hi:[1,0]
    v_pk_mul_f32 v[178:179], v[34:35], v[136:137] op_sel_hi:[1,0]
    v_exp_f32 v180, v172
    v_exp_f32 v181, v173
    v_exp_f32 v182, v174
    v_exp_f32 v183, v175
    v_exp_f32 v184, v176
    v_exp_f32 v185, v177
    v_exp_f32 v186, v178
    v_exp_f32 v187, v179
    v_pk_fma_f32 v[180:181], v[180:181], s[58:59], s[58:59]
    v_pk_fma_f32 v[182:183], v[182:183], s[58:59], s[58:59]
    v_pk_fma_f32 v[184:185], v[184:185], s[58:59], s[58:59]
    v_pk_fma_f32 v[186:187], v[186:187], s[58:59], s[58:59]
    v_rcp_f32 v180, v180
    v_rcp_f32 v181, v181
    v_rcp_f32 v182, v182
    v_rcp_f32 v183, v183
    v_rcp_f32 v184, v184
    v_rcp_f32 v185, v185
    v_rcp_f32 v186, v186
    v_rcp_f32 v187, v187
    v_pk_mul_f32 v[172:173], v[172:173], v[180:181]
    v_pk_mul_f32 v[174:175], v[174:175], v[182:183]
    v_pk_mul_f32 v[176:177], v[176:177], v[184:185]
    v_pk_mul_f32 v[178:179], v[178:179], v[186:187]
    v_cvt_pk_bf16_f32 v192, v172, v173
    v_cvt_pk_bf16_f32 v193, v174, v175
    v_cvt_pk_bf16_f32 v194, v176, v177
    v_cvt_pk_bf16_f32 v195, v178, v179
    ds_write_b128 v8, v[192:195] offset:0
    s_cbranch_scc1 Lsequen_m_pl0
    buffer_store_dwordx4 v[192:195], v4, s[20:23], s32 offen offset:0 sc1
    s_branch Lsequen_m_st0
Lsequen_m_pl0:
    buffer_store_dwordx4 v[192:195], v4, s[20:23], s32 offen offset:0
Lsequen_m_st0:
    v_pk_fma_f32 v[48:49], v[152:153], v[128:129], v[48:49] op_sel_hi:[1,0,1] neg_lo:[0,1,0] neg_hi:[0,1,0]
    v_pk_fma_f32 v[50:51], v[154:155], v[128:129], v[50:51] op_sel_hi:[1,0,1] neg_lo:[0,1,0] neg_hi:[0,1,0]
    v_pk_fma_f32 v[64:65], v[156:157], v[128:129], v[64:65] op_sel_hi:[1,0,1] neg_lo:[0,1,0] neg_hi:[0,1,0]
    v_pk_fma_f32 v[66:67], v[158:159], v[128:129], v[66:67] op_sel_hi:[1,0,1] neg_lo:[0,1,0] neg_hi:[0,1,0]
    v_pk_mul_f32 v[172:173], v[48:49], v[136:137] op_sel_hi:[1,0]
    v_pk_mul_f32 v[174:175], v[50:51], v[136:137] op_sel_hi:[1,0]
    v_pk_mul_f32 v[176:177], v[64:65], v[136:137] op_sel_hi:[1,0]
    v_pk_mul_f32 v[178:179], v[66:67], v[136:137] op_sel_hi:[1,0]
    v_exp_f32 v180, v172
    v_exp_f32 v181, v173
    v_exp_f32 v182, v174
    v_exp_f32 v183, v175
    v_exp_f32 v184, v176
    v_exp_f32 v185, v177
    v_exp_f32 v186, v178
    v_exp_f32 v187, v179
    v_pk_fma_f32 v[180:181], v[180:181], s[58:59], s[58:59]
    v_pk_fma_f32 v[182:183], v[182:183], s[58:59], s[58:59]
    v_pk_fma_f32 v[184:185], v[184:185], s[58:59], s[58:59]
    v_pk_fma_f32 v[186:187], v[186:187], s[58:59], s[58:59]
    v_rcp_f32 v180, v180
    v_rcp_f32 v181, v181
    v_rcp_f32 v182, v182
    v_rcp_f32 v183, v183
    v_rcp_f32 v184, v184
    v_rcp_f32 v185, v185
    v_rcp_f32 v186, v186
    v_rcp_f32 v187, v187
    v_pk_mul_f32 v[172:173], v[172:173], v[180:181]
    v_pk_mul_f32 v[174:175], v[174:175], v[182:183]
    v_pk_mul_f32 v[176:177], v[176:177], v[184:185]
    v_pk_mul_f32 v[178:179], v[178:179], v[186:187]
    v_cvt_pk_bf16_f32 v196, v172, v173
    v_cvt_pk_bf16_f32 v197, v174, v175
    v_cvt_pk_bf16_f32 v198, v176, v177
    v_cvt_pk_bf16_f32 v199, v178, v179
    ds_write_b128 v9, v[196:199] offset:0
    s_cbranch_scc1 Lsequen_m_pl1
    buffer_store_dwordx4 v[196:199], v4, s[20:23], s32 offen offset:1024 sc1
    s_branch Lsequen_m_st1
Lsequen_m_pl1:
    buffer_store_dwordx4 v[196:199], v4, s[20:23], s32 offen offset:1024
Lsequen_m_st1:
    v_pk_fma_f32 v[80:81], v[160:161], v[128:129], v[80:81] op_sel_hi:[1,0,1] neg_lo:[0,1,0] neg_hi:[0,1,0]
    v_pk_fma_f32 v[82:83], v[162:163], v[128:129], v[82:83] op_sel_hi:[1,0,1] neg_lo:[0,1,0] neg_hi:[0,1,0]
    v_pk_fma_f32 v[96:97], v[164:165], v[128:129], v[96:97] op_sel_hi:[1,0,1] neg_lo:[0,1,0] neg_hi:[0,1,0]
    v_pk_fma_f32 v[98:99], v[166:167], v[128:129], v[98:99] op_sel_hi:[1,0,1] neg_lo:[0,1,0] neg_hi:[0,1,0]
    v_pk_mul_f32 v[172:173], v[80:81], v[136:137] op_sel_hi:[1,0]
    v_pk_mul_f32 v[174:175], v[82:83], v[136:137] op_sel_hi:[1,0]
    v_pk_mul_f32 v[176:177], v[96:97], v[136:137] op_sel_hi:[1,0]
    v_pk_mul_f32 v[178:179], v[98:99], v[136:137] op_sel_hi:[1,0]
    v_exp_f32 v180, v172
    v_exp_f32 v181, v173
    v_exp_f32 v182, v174
    v_exp_f32 v183, v175
    v_exp_f32 v184, v176
    v_exp_f32 v185, v177
    v_exp_f32 v186, v178
    v_exp_f32 v187, v179
    v_pk_fma_f32 v[180:181], v[180:181], s[58:59], s[58:59]
    v_pk_fma_f32 v[182:183], v[182:183], s[58:59], s[58:59]
    v_pk_fma_f32 v[184:185], v[184:185], s[58:59], s[58:59]
    v_pk_fma_f32 v[186:187], v[186:187], s[58:59], s[58:59]
    v_rcp_f32 v180, v180
    v_rcp_f32 v181, v181
    v_rcp_f32 v182, v182
    v_rcp_f32 v183, v183
    v_rcp_f32 v184, v184
    v_rcp_f32 v185, v185
    v_rcp_f32 v186, v186
    v_rcp_f32 v187, v187
    v_pk_mul_f32 v[172:173], v[172:173], v[180:181]
    v_pk_mul_f32 v[174:175], v[174:175], v[182:183]
    v_pk_mul_f32 v[176:177], v[176:177], v[184:185]
    v_pk_mul_f32 v[178:179], v[178:179], v[186:187]
    v_cvt_pk_bf16_f32 v200, v172, v173
    v_cvt_pk_bf16_f32 v201, v174, v175
    v_cvt_pk_bf16_f32 v202, v176, v177
    v_cvt_pk_bf16_f32 v203, v178, v179
    ds_write_b128 v10, v[200:203] offset:0
    s_cbranch_scc1 Lsequen_m_pl2
    buffer_store_dwordx4 v[200:203], v4, s[20:23], s32 offen offset:2048 sc1
    s_branch Lsequen_m_st2
Lsequen_m_pl2:
    buffer_store_dwordx4 v[200:203], v4, s[20:23], s32 offen offset:2048
Lsequen_m_st2:
    v_pk_fma_f32 v[20:21], v[144:145], v[130:131], v[20:21] op_sel_hi:[1,0,1] neg_lo:[0,1,0] neg_hi:[0,1,0]
    v_pk_fma_f32 v[22:23], v[146:147], v[130:131], v[22:23] op_sel_hi:[1,0,1] neg_lo:[0,1,0] neg_hi:[0,1,0]
    v_pk_fma_f32 v[36:37], v[148:149], v[130:131], v[36:37] op_sel_hi:[1,0,1] neg_lo:[0,1,0] neg_hi:[0,1,0]
    v_pk_fma_f32 v[38:39], v[150:151], v[130:131], v[38:39] op_sel_hi:[1,0,1] neg_lo:[0,1,0] neg_hi:[0,1,0]
    v_pk_mul_f32 v[172:173], v[20:21], v[138:139] op_sel_hi:[1,0]
    v_pk_mul_f32 v[174:175], v[22:23], v[138:139] op_sel_hi:[1,0]
    v_pk_mul_f32 v[176:177], v[36:37], v[138:139] op_sel_hi:[1,0]
    v_pk_mul_f32 v[178:179], v[38:39], v[138:139] op_sel_hi:[1,0]
    v_exp_f32 v180, v172
    v_exp_f32 v181, v173
    v_exp_f32 v182, v174
    v_exp_f32 v183, v175
    v_exp_f32 v184, v176
    v_exp_f32 v185, v177
    v_exp_f32 v186, v178
    v_exp_f32 v187, v179
    v_pk_fma_f32 v[180:181], v[180:181], s[58:59], s[58:59]
    v_pk_fma_f32 v[182:183], v[182:183], s[58:59], s[58:59]
    v_pk_fma_f32 v[184:185], v[184:185], s[58:59], s[58:59]
    v_pk_fma_f32 v[186:187], v[186:187], s[58:59], s[58:59]
    v_rcp_f32 v180, v180
    v_rcp_f32 v181, v181
    v_rcp_f32 v182, v182
    v_rcp_f32 v183, v183
    v_rcp_f32 v184, v184
    v_rcp_f32 v185, v185
    v_rcp_f32 v186, v186
    v_rcp_f32 v187, v187
    v_pk_mul_f32 v[172:173], v[172:173], v[180:181]
    v_pk_mul_f32 v[174:175], v[174:175], v[182:183]
    v_pk_mul_f32 v[176:177], v[176:177], v[184:185]
    v_pk_mul_f32 v[178:179], v[178:179], v[186:187]
    v_cvt_pk_bf16_f32 v204, v172, v173
    v_cvt_pk_bf16_f32 v205, v174, v175
    v_cvt_pk_bf16_f32 v206, v176, v177
    v_cvt_pk_bf16_f32 v207, v178, v179
    ds_write_b128 v8, v[204:207] offset:2048
    s_cbranch_scc1 Lsequen_m_pl3
    buffer_store_dwordx4 v[204:207], v4, s[20:23], s33 offen offset:0 sc1
    s_branch Lsequen_m_st3
Lsequen_m_pl3:
    buffer_store_dwordx4 v[204:207], v4, s[20:23], s33 offen offset:0
Lsequen_m_st3:
    v_pk_fma_f32 v[52:53], v[152:153], v[130:131], v[52:53] op_sel_hi:[1,0,1] neg_lo:[0,1,0] neg_hi:[0,1,0]
    v_pk_fma_f32 v[54:55], v[154:155], v[130:131], v[54:55] op_sel_hi:[1,0,1] neg_lo:[0,1,0] neg_hi:[0,1,0]
    v_pk_fma_f32 v[68:69], v[156:157], v[130:131], v[68:69] op_sel_hi:[1,0,1] neg_lo:[0,1,0] neg_hi:[0,1,0]
    v_pk_fma_f32 v[70:71], v[158:159], v[130:131], v[70:71] op_sel_hi:[1,0,1] neg_lo:[0,1,0] neg_hi:[0,1,0]
    v_pk_mul_f32 v[172:173], v[52:53], v[138:139] op_sel_hi:[1,0]
    v_pk_mul_f32 v[174:175], v[54:55], v[138:139] op_sel_hi:[1,0]
    v_pk_mul_f32 v[176:177], v[68:69], v[138:139] op_sel_hi:[1,0]
    v_pk_mul_f32 v[178:179], v[70:71], v[138:139] op_sel_hi:[1,0]
    v_exp_f32 v180, v172
    v_exp_f32 v181, v173
    v_exp_f32 v182, v174
    v_exp_f32 v183, v175
    v_exp_f32 v184, v176
    v_exp_f32 v185, v177
    v_exp_f32 v186, v178
    v_exp_f32 v187, v179
    v_pk_fma_f32 v[180:181], v[180:181], s[58:59], s[58:59]
    v_pk_fma_f32 v[182:183], v[182:183], s[58:59], s[58:59]
    v_pk_fma_f32 v[184:185], v[184:185], s[58:59], s[58:59]
    v_pk_fma_f32 v[186:187], v[186:187], s[58:59], s[58:59]
    v_rcp_f32 v180, v180
    v_rcp_f32 v181, v181
    v_rcp_f32 v182, v182
    v_rcp_f32 v183, v183
    v_rcp_f32 v184, v184
    v_rcp_f32 v185, v185
    v_rcp_f32 v186, v186
    v_rcp_f32 v187, v187
    v_pk_mul_f32 v[172:173], v[172:173], v[180:181]
    v_pk_mul_f32 v[174:175], v[174:175], v[182:183]
    v_pk_mul_f32 v[176:177], v[176:177], v[184:185]
    v_pk_mul_f32 v[178:179], v[178:179], v[186:187]
    v_cvt_pk_bf16_f32 v192, v172, v173
    v_cvt_pk_bf16_f32 v193, v174, v175
    v_cvt_pk_bf16_f32 v194, v176, v177
    v_cvt_pk_bf16_f32 v195, v178, v179
    ds_write_b128 v9, v[192:195] offset:2048
    s_cbranch_scc1 Lsequen_m_pl4
    buffer_store_dwordx4 v[192:195], v4, s[20:23], s33 offen offset:1024 sc1
    s_branch Lsequen_m_st4
Lsequen_m_pl4:
    buffer_store_dwordx4 v[192:195], v4, s[20:23], s33 offen offset:1024
Lsequen_m_st4:
    v_pk_fma_f32 v[84:85], v[160:161], v[130:131], v[84:85] op_sel_hi:[1,0,1] neg_lo:[0,1,0] neg_hi:[0,1,0]
    v_pk_fma_f32 v[86:87], v[162:163], v[130:131], v[86:87] op_sel_hi:[1,0,1] neg_lo:[0,1,0] neg_hi:[0,1,0]
    v_pk_fma_f32 v[100:101], v[164:165], v[130:131], v[100:101] op_sel_hi:[1,0,1] neg_lo:[0,1,0] neg_hi:[0,1,0]
    v_pk_fma_f32 v[102:103], v[166:167], v[130:131], v[102:103] op_sel_hi:[1,0,1] neg_lo:[0,1,0] neg_hi:[0,1,0]
    v_pk_mul_f32 v[172:173], v[84:85], v[138:139] op_sel_hi:[1,0]
    v_pk_mul_f32 v[174:175], v[86:87], v[138:139] op_sel_hi:[1,0]
    v_pk_mul_f32 v[176:177], v[100:101], v[138:139] op_sel_hi:[1,0]
    v_pk_mul_f32 v[178:179], v[102:103], v[138:139] op_sel_hi:[1,0]
    v_exp_f32 v180, v172
    v_exp_f32 v181, v173
    v_exp_f32 v182, v174
    v_exp_f32 v183, v175
    v_exp_f32 v184, v176
    v_exp_f32 v185, v177
    v_exp_f32 v186, v178
    v_exp_f32 v187, v179
    v_pk_fma_f32 v[180:181], v[180:181], s[58:59], s[58:59]
    v_pk_fma_f32 v[182:183], v[182:183], s[58:59], s[58:59]
    v_pk_fma_f32 v[184:185], v[184:185], s[58:59], s[58:59]
    v_pk_fma_f32 v[186:187], v[186:187], s[58:59], s[58:59]
    v_rcp_f32 v180, v180
    v_rcp_f32 v181, v181
    v_rcp_f32 v182, v182
    v_rcp_f32 v183, v183
    v_rcp_f32 v184, v184
    v_rcp_f32 v185, v185
    v_rcp_f32 v186, v186
    v_rcp_f32 v187, v187
    v_pk_mul_f32 v[172:173], v[172:173], v[180:181]
    v_pk_mul_f32 v[174:175], v[174:175], v[182:183]
    v_pk_mul_f32 v[176:177], v[176:177], v[184:185]
    v_pk_mul_f32 v[178:179], v[178:179], v[186:187]
    v_cvt_pk_bf16_f32 v196, v172, v173
    v_cvt_pk_bf16_f32 v197, v174, v175
    v_cvt_pk_bf16_f32 v198, v176, v177
    v_cvt_pk_bf16_f32 v199, v178, v179
    ds_write_b128 v10, v[196:199] offset:2048
    s_cbranch_scc1 Lsequen_m_pl5
    buffer_store_dwordx4 v[196:199], v4, s[20:23], s33 offen offset:2048 sc1
    s_branch Lsequen_m_st5
Lsequen_m_pl5:
    buffer_store_dwordx4 v[196:199], v4, s[20:23], s33 offen offset:2048
Lsequen_m_st5:
    v_pk_fma_f32 v[112:113], v[168:169], v[128:129], v[112:113] op_sel_hi:[1,0,1] neg_lo:[0,1,0] neg_hi:[0,1,0]
    v_pk_fma_f32 v[114:115], v[170:171], v[128:129], v[114:115] op_sel_hi:[1,0,1] neg_lo:[0,1,0] neg_hi:[0,1,0]
    v_pk_fma_f32 v[116:117], v[168:169], v[130:131], v[116:117] op_sel_hi:[1,0,1] neg_lo:[0,1,0] neg_hi:[0,1,0]
    v_pk_fma_f32 v[118:119], v[170:171], v[130:131], v[118:119] op_sel_hi:[1,0,1] neg_lo:[0,1,0] neg_hi:[0,1,0]
    v_pk_mul_f32 v[172:173], v[112:113], v[136:137] op_sel_hi:[1,0]
    v_pk_mul_f32 v[174:175], v[114:115], v[136:137] op_sel_hi:[1,0]
    v_pk_mul_f32 v[176:177], v[116:117], v[138:139] op_sel_hi:[1,0]
    v_pk_mul_f32 v[178:179], v[118:119], v[138:139] op_sel_hi:[1,0]
    v_exp_f32 v180, v172
    v_exp_f32 v181, v173
    v_exp_f32 v182, v174
    v_exp_f32 v183, v175
    v_exp_f32 v184, v176
    v_exp_f32 v185, v177
    v_exp_f32 v186, v178
    v_exp_f32 v187, v179
    v_pk_fma_f32 v[180:181], v[180:181], s[58:59], s[58:59]
    v_pk_fma_f32 v[182:183], v[182:183], s[58:59], s[58:59]
    v_pk_fma_f32 v[184:185], v[184:185], s[58:59], s[58:59]
    v_pk_fma_f32 v[186:187], v[186:187], s[58:59], s[58:59]
    v_rcp_f32 v180, v180
    v_rcp_f32 v181, v181
    v_rcp_f32 v182, v182
    v_rcp_f32 v183, v183
    v_rcp_f32 v184, v184
    v_rcp_f32 v185, v185
    v_rcp_f32 v186, v186
    v_rcp_f32 v187, v187
    v_pk_mul_f32 v[172:173], v[172:173], v[180:181]
    v_pk_mul_f32 v[174:175], v[174:175], v[182:183]
    v_pk_mul_f32 v[176:177], v[176:177], v[184:185]
    v_pk_mul_f32 v[178:179], v[178:179], v[186:187]
    v_cvt_pk_bf16_f32 v200, v172, v173
    v_cvt_pk_bf16_f32 v201, v174, v175
    v_cvt_pk_bf16_f32 v202, v176, v177
    v_cvt_pk_bf16_f32 v203, v178, v179
    ds_write_b64 v11, v[200:201] offset:0
    ds_write_b64 v11, v[202:203] offset:2048
    s_cbranch_scc1 Lsequen_m_pl6
    buffer_store_dwordx2 v[200:201], v5, s[20:23], s32 offen sc1
    buffer_store_dwordx2 v[202:203], v5, s[20:23], s33 offen sc1
    s_branch Lsequen_m_st6
Lsequen_m_pl6:
    buffer_store_dwordx2 v[200:201], v5, s[20:23], s32 offen
    buffer_store_dwordx2 v[202:203], v5, s[20:23], s33 offen
Lsequen_m_st6:
    v_pk_fma_f32 v[24:25], v[144:145], v[132:133], v[24:25] op_sel_hi:[1,0,1] neg_lo:[0,1,0] neg_hi:[0,1,0]
    v_pk_fma_f32 v[26:27], v[146:147], v[132:133], v[26:27] op_sel_hi:[1,0,1] neg_lo:[0,1,0] neg_hi:[0,1,0]
    v_pk_fma_f32 v[40:41], v[148:149], v[132:133], v[40:41] op_sel_hi:[1,0,1] neg_lo:[0,1,0] neg_hi:[0,1,0]
    v_pk_fma_f32 v[42:43], v[150:151], v[132:133], v[42:43] op_sel_hi:[1,0,1] neg_lo:[0,1,0] neg_hi:[0,1,0]
    v_pk_mul_f32 v[172:173], v[24:25], v[140:141] op_sel_hi:[1,0]
    v_pk_mul_f32 v[174:175], v[26:27], v[140:141] op_sel_hi:[1,0]
    v_pk_mul_f32 v[176:177], v[40:41], v[140:141] op_sel_hi:[1,0]
    v_pk_mul_f32 v[178:179], v[42:43], v[140:141] op_sel_hi:[1,0]
    v_exp_f32 v180, v172
    v_exp_f32 v181, v173
    v_exp_f32 v182, v174
    v_exp_f32 v183, v175
    v_exp_f32 v184, v176
    v_exp_f32 v185, v177
    v_exp_f32 v186, v178
    v_exp_f32 v187, v179
    v_pk_fma_f32 v[180:181], v[180:181], s[58:59], s[58:59]
    v_pk_fma_f32 v[182:183], v[182:183], s[58:59], s[58:59]
    v_pk_fma_f32 v[184:185], v[184:185], s[58:59], s[58:59]
    v_pk_fma_f32 v[186:187], v[186:187], s[58:59], s[58:59]
    v_rcp_f32 v180, v180
    v_rcp_f32 v181, v181
    v_rcp_f32 v182, v182
    v_rcp_f32 v183, v183
    v_rcp_f32 v184, v184
    v_rcp_f32 v185, v185
    v_rcp_f32 v186, v186
    v_rcp_f32 v187, v187
    v_pk_mul_f32 v[172:173], v[172:173], v[180:181]
    v_pk_mul_f32 v[174:175], v[174:175], v[182:183]
    v_pk_mul_f32 v[176:177], v[176:177], v[184:185]
    v_pk_mul_f32 v[178:179], v[178:179], v[186:187]
    v_cvt_pk_bf16_f32 v204, v172, v173
    v_cvt_pk_bf16_f32 v205, v174, v175
    v_cvt_pk_bf16_f32 v206, v176, v177
    v_cvt_pk_bf16_f32 v207, v178, v179
    ds_write_b128 v8, v[204:207] offset:4096
    s_cbranch_scc1 Lsequen_m_pl7
    buffer_store_dwordx4 v[204:207], v4, s[20:23], s34 offen offset:0 sc1
    s_branch Lsequen_m_st7
Lsequen_m_pl7:
    buffer_store_dwordx4 v[204:207], v4, s[20:23], s34 offen offset:0
Lsequen_m_st7:
    v_pk_fma_f32 v[56:57], v[152:153], v[132:133], v[56:57] op_sel_hi:[1,0,1] neg_lo:[0,1,0] neg_hi:[0,1,0]
    v_pk_fma_f32 v[58:59], v[154:155], v[132:133], v[58:59] op_sel_hi:[1,0,1] neg_lo:[0,1,0] neg_hi:[0,1,0]
    v_pk_fma_f32 v[72:73], v[156:157], v[132:133], v[72:73] op_sel_hi:[1,0,1] neg_lo:[0,1,0] neg_hi:[0,1,0]
    v_pk_fma_f32 v[74:75], v[158:159], v[132:133], v[74:75] op_sel_hi:[1,0,1] neg_lo:[0,1,0] neg_hi:[0,1,0]
    v_pk_mul_f32 v[172:173], v[56:57], v[140:141] op_sel_hi:[1,0]
    v_pk_mul_f32 v[174:175], v[58:59], v[140:141] op_sel_hi:[1,0]
    v_pk_mul_f32 v[176:177], v[72:73], v[140:141] op_sel_hi:[1,0]
    v_pk_mul_f32 v[178:179], v[74:75], v[140:141] op_sel_hi:[1,0]
    v_exp_f32 v180, v172
    v_exp_f32 v181, v173
    v_exp_f32 v182, v174
    v_exp_f32 v183, v175
    v_exp_f32 v184, v176
    v_exp_f32 v185, v177
    v_exp_f32 v186, v178
    v_exp_f32 v187, v179
    v_pk_fma_f32 v[180:181], v[180:181], s[58:59], s[58:59]
    v_pk_fma_f32 v[182:183], v[182:183], s[58:59], s[58:59]
    v_pk_fma_f32 v[184:185], v[184:185], s[58:59], s[58:59]
    v_pk_fma_f32 v[186:187], v[186:187], s[58:59], s[58:59]
    v_rcp_f32 v180, v180
    v_rcp_f32 v181, v181
    v_rcp_f32 v182, v182
    v_rcp_f32 v183, v183
    v_rcp_f32 v184, v184
    v_rcp_f32 v185, v185
    v_rcp_f32 v186, v186
    v_rcp_f32 v187, v187
    v_pk_mul_f32 v[172:173], v[172:173], v[180:181]
    v_pk_mul_f32 v[174:175], v[174:175], v[182:183]
    v_pk_mul_f32 v[176:177], v[176:177], v[184:185]
    v_pk_mul_f32 v[178:179], v[178:179], v[186:187]
    v_cvt_pk_bf16_f32 v192, v172, v173
    v_cvt_pk_bf16_f32 v193, v174, v175
    v_cvt_pk_bf16_f32 v194, v176, v177
    v_cvt_pk_bf16_f32 v195, v178, v179
    ds_write_b128 v9, v[192:195] offset:4096
    s_cbranch_scc1 Lsequen_m_pl8
    buffer_store_dwordx4 v[192:195], v4, s[20:23], s34 offen offset:1024 sc1
    s_branch Lsequen_m_st8
Lsequen_m_pl8:
    buffer_store_dwordx4 v[192:195], v4, s[20:23], s34 offen offset:1024
Lsequen_m_st8:
    v_pk_fma_f32 v[88:89], v[160:161], v[132:133], v[88:89] op_sel_hi:[1,0,1] neg_lo:[0,1,0] neg_hi:[0,1,0]
    v_pk_fma_f32 v[90:91], v[162:163], v[132:133], v[90:91] op_sel_hi:[1,0,1] neg_lo:[0,1,0] neg_hi:[0,1,0]
    v_pk_fma_f32 v[104:105], v[164:165], v[132:133], v[104:105] op_sel_hi:[1,0,1] neg_lo:[0,1,0] neg_hi:[0,1,0]
    v_pk_fma_f32 v[106:107], v[166:167], v[132:133], v[106:107] op_sel_hi:[1,0,1] neg_lo:[0,1,0] neg_hi:[0,1,0]
    v_pk_mul_f32 v[172:173], v[88:89], v[140:141] op_sel_hi:[1,0]
    v_pk_mul_f32 v[174:175], v[90:91], v[140:141] op_sel_hi:[1,0]
    v_pk_mul_f32 v[176:177], v[104:105], v[140:141] op_sel_hi:[1,0]
    v_pk_mul_f32 v[178:179], v[106:107], v[140:141] op_sel_hi:[1,0]
    v_exp_f32 v180, v172
    v_exp_f32 v181, v173
    v_exp_f32 v182, v174
    v_exp_f32 v183, v175
    v_exp_f32 v184, v176
    v_exp_f32 v185, v177
    v_exp_f32 v186, v178
    v_exp_f32 v187, v179
    v_pk_fma_f32 v[180:181], v[180:181], s[58:59], s[58:59]
    v_pk_fma_f32 v[182:183], v[182:183], s[58:59], s[58:59]
    v_pk_fma_f32 v[184:185], v[184:185], s[58:59], s[58:59]
    v_pk_fma_f32 v[186:187], v[186:187], s[58:59], s[58:59]
    v_rcp_f32 v180, v180
    v_rcp_f32 v181, v181
    v_rcp_f32 v182, v182
    v_rcp_f32 v183, v183
    v_rcp_f32 v184, v184
    v_rcp_f32 v185, v185
    v_rcp_f32 v186, v186
    v_rcp_f32 v187, v187
    v_pk_mul_f32 v[172:173], v[172:173], v[180:181]
    v_pk_mul_f32 v[174:175], v[174:175], v[182:183]
    v_pk_mul_f32 v[176:177], v[176:177], v[184:185]
    v_pk_mul_f32 v[178:179], v[178:179], v[186:187]
    v_cvt_pk_bf16_f32 v196, v172, v173
    v_cvt_pk_bf16_f32 v197, v174, v175
    v_cvt_pk_bf16_f32 v198, v176, v177
    v_cvt_pk_bf16_f32 v199, v178, v179
    ds_write_b128 v10, v[196:199] offset:4096
    s_cbranch_scc1 Lsequen_m_pl9
    buffer_store_dwordx4 v[196:199], v4, s[20:23], s34 offen offset:2048 sc1
    s_branch Lsequen_m_st9
Lsequen_m_pl9:
    buffer_store_dwordx4 v[196:199], v4, s[20:23], s34 offen offset:2048
Lsequen_m_st9:
    v_pk_fma_f32 v[28:29], v[144:145], v[134:135], v[28:29] op_sel_hi:[1,0,1] neg_lo:[0,1,0] neg_hi:[0,1,0]
    v_pk_fma_f32 v[30:31], v[146:147], v[134:135], v[30:31] op_sel_hi:[1,0,1] neg_lo:[0,1,0] neg_hi:[0,1,0]
    v_pk_fma_f32 v[44:45], v[148:149], v[134:135], v[44:45] op_sel_hi:[1,0,1] neg_lo:[0,1,0] neg_hi:[0,1,0]
    v_pk_fma_f32 v[46:47], v[150:151], v[134:135], v[46:47] op_sel_hi:[1,0,1] neg_lo:[0,1,0] neg_hi:[0,1,0]
    v_pk_mul_f32 v[172:173], v[28:29], v[142:143] op_sel_hi:[1,0]
    v_pk_mul_f32 v[174:175], v[30:31], v[142:143] op_sel_hi:[1,0]
    v_pk_mul_f32 v[176:177], v[44:45], v[142:143] op_sel_hi:[1,0]
    v_pk_mul_f32 v[178:179], v[46:47], v[142:143] op_sel_hi:[1,0]
    v_exp_f32 v180, v172
    v_exp_f32 v181, v173
    v_exp_f32 v182, v174
    v_exp_f32 v183, v175
    v_exp_f32 v184, v176
    v_exp_f32 v185, v177
    v_exp_f32 v186, v178
    v_exp_f32 v187, v179
    v_pk_fma_f32 v[180:181], v[180:181], s[58:59], s[58:59]
    v_pk_fma_f32 v[182:183], v[182:183], s[58:59], s[58:59]
    v_pk_fma_f32 v[184:185], v[184:185], s[58:59], s[58:59]
    v_pk_fma_f32 v[186:187], v[186:187], s[58:59], s[58:59]
    v_rcp_f32 v180, v180
    v_rcp_f32 v181, v181
    v_rcp_f32 v182, v182
    v_rcp_f32 v183, v183
    v_rcp_f32 v184, v184
    v_rcp_f32 v185, v185
    v_rcp_f32 v186, v186
    v_rcp_f32 v187, v187
    v_pk_mul_f32 v[172:173], v[172:173], v[180:181]
    v_pk_mul_f32 v[174:175], v[174:175], v[182:183]
    v_pk_mul_f32 v[176:177], v[176:177], v[184:185]
    v_pk_mul_f32 v[178:179], v[178:179], v[186:187]
    v_cvt_pk_bf16_f32 v200, v172, v173
    v_cvt_pk_bf16_f32 v201, v174, v175
    v_cvt_pk_bf16_f32 v202, v176, v177
    v_cvt_pk_bf16_f32 v203, v178, v179
    ds_write_b128 v8, v[200:203] offset:6144
    s_cbranch_scc1 Lsequen_m_pl10
    buffer_store_dwordx4 v[200:203], v4, s[20:23], s35 offen offset:0 sc1
    s_branch Lsequen_m_st10
Lsequen_m_pl10:
    buffer_store_dwordx4 v[200:203], v4, s[20:23], s35 offen offset:0
Lsequen_m_st10:
    v_pk_fma_f32 v[60:61], v[152:153], v[134:135], v[60:61] op_sel_hi:[1,0,1] neg_lo:[0,1,0] neg_hi:[0,1,0]
    v_pk_fma_f32 v[62:63], v[154:155], v[134:135], v[62:63] op_sel_hi:[1,0,1] neg_lo:[0,1,0] neg_hi:[0,1,0]
    v_pk_fma_f32 v[76:77], v[156:157], v[134:135], v[76:77] op_sel_hi:[1,0,1] neg_lo:[0,1,0] neg_hi:[0,1,0]
    v_pk_fma_f32 v[78:79], v[158:159], v[134:135], v[78:79] op_sel_hi:[1,0,1] neg_lo:[0,1,0] neg_hi:[0,1,0]
    v_pk_mul_f32 v[172:173], v[60:61], v[142:143] op_sel_hi:[1,0]
    v_pk_mul_f32 v[174:175], v[62:63], v[142:143] op_sel_hi:[1,0]
    v_pk_mul_f32 v[176:177], v[76:77], v[142:143] op_sel_hi:[1,0]
    v_pk_mul_f32 v[178:179], v[78:79], v[142:143] op_sel_hi:[1,0]
    v_exp_f32 v180, v172
    v_exp_f32 v181, v173
    v_exp_f32 v182, v174
    v_exp_f32 v183, v175
    v_exp_f32 v184, v176
    v_exp_f32 v185, v177
    v_exp_f32 v186, v178
    v_exp_f32 v187, v179
    v_pk_fma_f32 v[180:181], v[180:181], s[58:59], s[58:59]
    v_pk_fma_f32 v[182:183], v[182:183], s[58:59], s[58:59]
    v_pk_fma_f32 v[184:185], v[184:185], s[58:59], s[58:59]
    v_pk_fma_f32 v[186:187], v[186:187], s[58:59], s[58:59]
    v_rcp_f32 v180, v180
    v_rcp_f32 v181, v181
    v_rcp_f32 v182, v182
    v_rcp_f32 v183, v183
    v_rcp_f32 v184, v184
    v_rcp_f32 v185, v185
    v_rcp_f32 v186, v186
    v_rcp_f32 v187, v187
    v_pk_mul_f32 v[172:173], v[172:173], v[180:181]
    v_pk_mul_f32 v[174:175], v[174:175], v[182:183]
    v_pk_mul_f32 v[176:177], v[176:177], v[184:185]
    v_pk_mul_f32 v[178:179], v[178:179], v[186:187]
    v_cvt_pk_bf16_f32 v204, v172, v173
    v_cvt_pk_bf16_f32 v205, v174, v175
    v_cvt_pk_bf16_f32 v206, v176, v177
    v_cvt_pk_bf16_f32 v207, v178, v179
    ds_write_b128 v9, v[204:207] offset:6144
    s_cbranch_scc1 Lsequen_m_pl11
    buffer_store_dwordx4 v[204:207], v4, s[20:23], s35 offen offset:1024 sc1
    s_branch Lsequen_m_st11
Lsequen_m_pl11:
    buffer_store_dwordx4 v[204:207], v4, s[20:23], s35 offen offset:1024
Lsequen_m_st11:
    v_pk_fma_f32 v[92:93], v[160:161], v[134:135], v[92:93] op_sel_hi:[1,0,1] neg_lo:[0,1,0] neg_hi:[0,1,0]
    v_pk_fma_f32 v[94:95], v[162:163], v[134:135], v[94:95] op_sel_hi:[1,0,1] neg_lo:[0,1,0] neg_hi:[0,1,0]
    v_pk_fma_f32 v[108:109], v[164:165], v[134:135], v[108:109] op_sel_hi:[1,0,1] neg_lo:[0,1,0] neg_hi:[0,1,0]
    v_pk_fma_f32 v[110:111], v[166:167], v[134:135], v[110:111] op_sel_hi:[1,0,1] neg_lo:[0,1,0] neg_hi:[0,1,0]
    v_pk_mul_f32 v[172:173], v[92:93], v[142:143] op_sel_hi:[1,0]
    v_pk_mul_f32 v[174:175], v[94:95], v[142:143] op_sel_hi:[1,0]
    v_pk_mul_f32 v[176:177], v[108:109], v[142:143] op_sel_hi:[1,0]
    v_pk_mul_f32 v[178:179], v[110:111], v[142:143] op_sel_hi:[1,0]
    v_exp_f32 v180, v172
    v_exp_f32 v181, v173
    v_exp_f32 v182, v174
    v_exp_f32 v183, v175
    v_exp_f32 v184, v176
    v_exp_f32 v185, v177
    v_exp_f32 v186, v178
    v_exp_f32 v187, v179
    v_pk_fma_f32 v[180:181], v[180:181], s[58:59], s[58:59]
    v_pk_fma_f32 v[182:183], v[182:183], s[58:59], s[58:59]
    v_pk_fma_f32 v[184:185], v[184:185], s[58:59], s[58:59]
    v_pk_fma_f32 v[186:187], v[186:187], s[58:59], s[58:59]
    v_rcp_f32 v180, v180
    v_rcp_f32 v181, v181
    v_rcp_f32 v182, v182
    v_rcp_f32 v183, v183
    v_rcp_f32 v184, v184
    v_rcp_f32 v185, v185
    v_rcp_f32 v186, v186
    v_rcp_f32 v187, v187
    v_pk_mul_f32 v[172:173], v[172:173], v[180:181]
    v_pk_mul_f32 v[174:175], v[174:175], v[182:183]
    v_pk_mul_f32 v[176:177], v[176:177], v[184:185]
    v_pk_mul_f32 v[178:179], v[178:179], v[186:187]
    v_cvt_pk_bf16_f32 v192, v172, v173
    v_cvt_pk_bf16_f32 v193, v174, v175
    v_cvt_pk_bf16_f32 v194, v176, v177
    v_cvt_pk_bf16_f32 v195, v178, v179
    ds_write_b128 v10, v[192:195] offset:6144
    s_cbranch_scc1 Lsequen_m_pl12
    buffer_store_dwordx4 v[192:195], v4, s[20:23], s35 offen offset:2048 sc1
    s_branch Lsequen_m_st12
Lsequen_m_pl12:
    buffer_store_dwordx4 v[192:195], v4, s[20:23], s35 offen offset:2048
Lsequen_m_st12:
    v_pk_fma_f32 v[120:121], v[168:169], v[132:133], v[120:121] op_sel_hi:[1,0,1] neg_lo:[0,1,0] neg_hi:[0,1,0]
    v_pk_fma_f32 v[122:123], v[170:171], v[132:133], v[122:123] op_sel_hi:[1,0,1] neg_lo:[0,1,0] neg_hi:[0,1,0]
    v_pk_fma_f32 v[124:125], v[168:169], v[134:135], v[124:125] op_sel_hi:[1,0,1] neg_lo:[0,1,0] neg_hi:[0,1,0]
    v_pk_fma_f32 v[126:127], v[170:171], v[134:135], v[126:127] op_sel_hi:[1,0,1] neg_lo:[0,1,0] neg_hi:[0,1,0]
    v_pk_mul_f32 v[172:173], v[120:121], v[140:141] op_sel_hi:[1,0]
    v_pk_mul_f32 v[174:175], v[122:123], v[140:141] op_sel_hi:[1,0]
    v_pk_mul_f32 v[176:177], v[124:125], v[142:143] op_sel_hi:[1,0]
    v_pk_mul_f32 v[178:179], v[126:127], v[142:143] op_sel_hi:[1,0]
    v_exp_f32 v180, v172
    v_exp_f32 v181, v173
    v_exp_f32 v182, v174
    v_exp_f32 v183, v175
    v_exp_f32 v184, v176
    v_exp_f32 v185, v177
    v_exp_f32 v186, v178
    v_exp_f32 v187, v179
    v_pk_fma_f32 v[180:181], v[180:181], s[58:59], s[58:59]
    v_pk_fma_f32 v[182:183], v[182:183], s[58:59], s[58:59]
    v_pk_fma_f32 v[184:185], v[184:185], s[58:59], s[58:59]
    v_pk_fma_f32 v[186:187], v[186:187], s[58:59], s[58:59]
    v_rcp_f32 v180, v180
    v_rcp_f32 v181, v181
    v_rcp_f32 v182, v182
    v_rcp_f32 v183, v183
    v_rcp_f32 v184, v184
    v_rcp_f32 v185, v185
    v_rcp_f32 v186, v186
    v_rcp_f32 v187, v187
    v_pk_mul_f32 v[172:173], v[172:173], v[180:181]
    v_pk_mul_f32 v[174:175], v[174:175], v[182:183]
    v_pk_mul_f32 v[176:177], v[176:177], v[184:185]
    v_pk_mul_f32 v[178:179], v[178:179], v[186:187]
    v_cvt_pk_bf16_f32 v196, v172, v173
    v_cvt_pk_bf16_f32 v197, v174, v175
    v_cvt_pk_bf16_f32 v198, v176, v177
    v_cvt_pk_bf16_f32 v199, v178, v179
    ds_write_b64 v11, v[196:197] offset:4096
    ds_write_b64 v11, v[198:199] offset:6144
    s_cbranch_scc1 Lsequen_m_pl13
    buffer_store_dwordx2 v[196:197], v5, s[20:23], s34 offen sc1
    buffer_store_dwordx2 v[198:199], v5, s[20:23], s35 offen sc1
    s_branch Lsequen_m_st13
Lsequen_m_pl13:
    buffer_store_dwordx2 v[196:197], v5, s[20:23], s34 offen
    buffer_store_dwordx2 v[198:199], v5, s[20:23], s35 offen
Lsequen_m_st13:
    v_mov_b32 v2, v15
    v_bfe_u32 v3, v0, 2, 2
    v_and_b32 v4, 3, v0
    v_lshl_add_u32 v7, v2, 2, v3
    v_and_b32 v5, 7, v7
    v_lshlrev_b32 v13, 8, v7
    v_lshl_add_u32 v13, v4, 3, v13
    v_add_u32 v13, 16384, v13
    s_lshl_b32 s26, s25, 2
    s_add_u32 s27, s26, 0
    v_xor_b32 v14, s27, v5
    v_lshl_add_u32 v8, v14, 5, v13
    s_add_u32 s27, s26, 1
    v_xor_b32 v14, s27, v5
    v_lshl_add_u32 v9, v14, 5, v13
    s_add_u32 s27, s26, 2
    v_xor_b32 v14, s27, v5
    v_lshl_add_u32 v10, v14, 5, v13
    s_add_u32 s27, s26, 3
    v_xor_b32 v14, s27, v5
    v_lshl_add_u32 v11, v14, 5, v13
    s_lshl_b32 s26, s24, 12
    v_lshl_add_u32 v12, v0, 4, s26
    v_mov_b32 v16, 0
    v_mov_b32 v17, 0
    v_mov_b32 v18, 0
    v_mov_b32 v19, 0
    v_mov_b32 v20, 0
    v_mov_b32 v21, 0
    v_mov_b32 v22, 0
    v_mov_b32 v23, 0
    v_mov_b32 v24, 0
    v_mov_b32 v25, 0
    v_mov_b32 v26, 0
    v_mov_b32 v27, 0
    v_mov_b32 v28, 0
    v_mov_b32 v29, 0
    v_mov_b32 v30, 0
    v_mov_b32 v31, 0
    v_mov_b32 v32, 0
    v_mov_b32 v33, 0
    v_mov_b32 v34, 0
    v_mov_b32 v35, 0
    v_mov_b32 v36, 0
    v_mov_b32 v37, 0
    v_mov_b32 v38, 0
    v_mov_b32 v39, 0
    v_mov_b32 v40, 0
    v_mov_b32 v41, 0
    v_mov_b32 v42, 0
    v_mov_b32 v43, 0
    v_mov_b32 v44, 0
    v_mov_b32 v45, 0
    v_mov_b32 v46, 0
    v_mov_b32 v47, 0
    v_mov_b32 v48, 0
    v_mov_b32 v49, 0
    v_mov_b32 v50, 0
    v_mov_b32 v51, 0
    v_mov_b32 v52, 0
    v_mov_b32 v53, 0
    v_mov_b32 v54, 0
    v_mov_b32 v55, 0
    v_mov_b32 v56, 0
    v_mov_b32 v57, 0
    v_mov_b32 v58, 0
    v_mov_b32 v59, 0
    v_mov_b32 v60, 0
    v_mov_b32 v61, 0
    v_mov_b32 v62, 0
    v_mov_b32 v63, 0
    v_mov_b32 v64, 0
    v_mov_b32 v65, 0
    v_mov_b32 v66, 0
    v_mov_b32 v67, 0
    v_mov_b32 v68, 0
    v_mov_b32 v69, 0
    v_mov_b32 v70, 0
    v_mov_b32 v71, 0
    v_mov_b32 v72, 0
    v_mov_b32 v73, 0
    v_mov_b32 v74, 0
    v_mov_b32 v75, 0
    v_mov_b32 v76, 0
    v_mov_b32 v77, 0
    v_mov_b32 v78, 0
    v_mov_b32 v79, 0
    v_mov_b32 v13, 1
    s_lshl_b32 s26, s2, 11
    s_add_u32 s26, s26, 0xd00300
    v_mov_b32 v14, 0
    v_mov_b32 v216, s98
    v_mov_b32 v217, s99
    s_waitcnt vmcnt(0)
    s_mov_b64 exec, 1
    ds_add_rtn_u32 v1, v6, v13
    s_waitcnt lgkmcnt(0)
    v_readfirstlane_b32 s27, v1
    s_cmp_eq_u32 s27, 3
    s_cbranch_scc0 Lsequen_m_noflag
    s_cmp_eq_u32 s54, 1
    s_cbranch_scc1 Lsequen_m_pl14
    buffer_store_dwordx2 v[216:217], v14, s[20:23], s26 offen sc1
    s_branch Lsequen_m_st14
Lsequen_m_pl14:
    buffer_store_dwordx2 v[216:217], v14, s[20:23], s26 offen
Lsequen_m_st14:
Lsequen_m_noflag:
    s_mov_b64 exec, -1
    v_bfe_u32 v6, v7, 1, 2
    s_mov_b32 s28, 0
    s_mov_b32 s29, 0
    s_add_u32 s61, s12, s10
    s_cmp_eq_u32 s61, 0
    s_cselect_b32 s61, 16, 99
    s_barrier
    ds_read_b128 v[96:99], v12 offset:0
    ds_read_b128 v[100:103], v12 offset:2048
    ds_read_b128 v[104:107], v12 offset:8192
    ds_read_b128 v[108:111], v12 offset:10240
    ds_read_b64_tr_b16 v[80:81], v8 offset:0
    ds_read_b64_tr_b16 v[82:83], v8 offset:4096
    ds_read_b64_tr_b16 v[84:85], v9 offset:0
    ds_read_b64_tr_b16 v[86:87], v9 offset:4096
    ds_read_b64_tr_b16 v[88:89], v10 offset:0
    ds_read_b64_tr_b16 v[90:91], v10 offset:4096
    ds_read_b64_tr_b16 v[92:93], v11 offset:0
    ds_read_b64_tr_b16 v[94:95], v11 offset:4096
Lsequen_m_c2loop:
    s_waitcnt lgkmcnt(6)
    v_mfma_f32_16x16x32_bf16 v[16:19], v[80:83], v[96:99], v[16:19]
    ds_read_b128 v[128:131], v12 offset:1024
    ds_read_b128 v[132:135], v12 offset:3072
    v_mfma_f32_16x16x32_bf16 v[20:23], v[80:83], v[100:103], v[20:23]
    ds_read_b128 v[136:139], v12 offset:9216
    ds_read_b128 v[140:143], v12 offset:11264
    v_mfma_f32_16x16x32_bf16 v[24:27], v[80:83], v[104:107], v[24:27]
    ds_read_b64_tr_b16 v[112:113], v8 offset:8192
    ds_read_b64_tr_b16 v[114:115], v8 offset:12288
    v_mfma_f32_16x16x32_bf16 v[28:31], v[80:83], v[108:111], v[28:31]
    ds_read_b64_tr_b16 v[116:117], v9 offset:8192
    ds_read_b64_tr_b16 v[118:119], v9 offset:12288
    s_waitcnt lgkmcnt(12)
    v_mfma_f32_16x16x32_bf16 v[32:35], v[84:87], v[96:99], v[32:35]
    ds_read_b64_tr_b16 v[120:121], v10 offset:8192
    ds_read_b64_tr_b16 v[122:123], v10 offset:12288
    v_mfma_f32_16x16x32_bf16 v[36:39], v[84:87], v[100:103], v[36:39]
    ds_read_b64_tr_b16 v[124:125], v11 offset:8192
    ds_read_b64_tr_b16 v[126:127], v11 offset:12288
    v_mfma_f32_16x16x32_bf16 v[40:43], v[84:87], v[104:107], v[40:43]
    s_add_u32 s29, s29, 1
    v_mfma_f32_16x16x32_bf16 v[44:47], v[84:87], v[108:111], v[44:47]
    s_mov_b32 s30, 32768
    s_waitcnt lgkmcnt(14)
    v_mfma_f32_16x16x32_bf16 v[48:51], v[88:91], v[96:99], v[48:51]
    s_cmp_eq_u32 s29, 4
    v_mfma_f32_16x16x32_bf16 v[52:55], v[88:91], v[100:103], v[52:55]
    s_cselect_b32 s30, -98304, s30
    v_mfma_f32_16x16x32_bf16 v[56:59], v[88:91], v[104:107], v[56:59]
    s_cselect_b32 s29, 0, s29
    v_mfma_f32_16x16x32_bf16 v[60:63], v[88:91], v[108:111], v[60:63]
    s_add_u32 s28, s28, 1
    s_waitcnt lgkmcnt(12)
    v_mfma_f32_16x16x32_bf16 v[64:67], v[92:95], v[96:99], v[64:67]
    v_mfma_f32_16x16x32_bf16 v[68:71], v[92:95], v[100:103], v[68:71]
    v_mfma_f32_16x16x32_bf16 v[72:75], v[92:95], v[104:107], v[72:75]
    v_mfma_f32_16x16x32_bf16 v[76:79], v[92:95], v[108:111], v[76:79]
    s_waitcnt lgkmcnt(6)
    v_mfma_f32_16x16x32_bf16 v[16:19], v[112:115], v[128:131], v[16:19]
    v_mfma_f32_16x16x32_bf16 v[20:23], v[112:115], v[132:135], v[20:23]
    v_mfma_f32_16x16x32_bf16 v[24:27], v[112:115], v[136:139], v[24:27]
    v_mfma_f32_16x16x32_bf16 v[28:31], v[112:115], v[140:143], v[28:31]
    s_waitcnt lgkmcnt(0)
    s_barrier
    v_mfma_f32_16x16x32_bf16 v[32:35], v[116:119], v[128:131], v[32:35]
    v_add_u32 v12, s30, v12
    v_add_u32 v8, s30, v8
    v_mfma_f32_16x16x32_bf16 v[36:39], v[116:119], v[132:135], v[36:39]
    v_add_u32 v9, s30, v9
    v_add_u32 v10, s30, v10
    v_mfma_f32_16x16x32_bf16 v[40:43], v[116:119], v[136:139], v[40:43]
    v_add_u32 v11, s30, v11
    ds_read_b128 v[96:99], v12 offset:0
    v_mfma_f32_16x16x32_bf16 v[44:47], v[116:119], v[140:143], v[44:47]
    ds_read_b128 v[100:103], v12 offset:2048
    ds_read_b128 v[104:107], v12 offset:8192
    v_mfma_f32_16x16x32_bf16 v[48:51], v[120:123], v[128:131], v[48:51]
    ds_read_b128 v[108:111], v12 offset:10240
    ds_read_b64_tr_b16 v[80:81], v8 offset:0
    v_mfma_f32_16x16x32_bf16 v[52:55], v[120:123], v[132:135], v[52:55]
    ds_read_b64_tr_b16 v[82:83], v8 offset:4096
    ds_read_b64_tr_b16 v[84:85], v9 offset:0
    v_mfma_f32_16x16x32_bf16 v[56:59], v[120:123], v[136:139], v[56:59]
    ds_read_b64_tr_b16 v[86:87], v9 offset:4096
    v_mfma_f32_16x16x32_bf16 v[60:63], v[120:123], v[140:143], v[60:63]
    ds_read_b64_tr_b16 v[88:89], v10 offset:0
    v_mfma_f32_16x16x32_bf16 v[64:67], v[124:127], v[128:131], v[64:67]
    ds_read_b64_tr_b16 v[90:91], v10 offset:4096
    v_mfma_f32_16x16x32_bf16 v[68:71], v[124:127], v[132:135], v[68:71]
    ds_read_b64_tr_b16 v[92:93], v11 offset:0
    v_mfma_f32_16x16x32_bf16 v[72:75], v[124:127], v[136:139], v[72:75]
    ds_read_b64_tr_b16 v[94:95], v11 offset:4096
    v_mfma_f32_16x16x32_bf16 v[76:79], v[124:127], v[140:143], v[76:79]
    s_cmp_lt_u32 s28, 28
    s_cbranch_scc1 Lsequen_m_c2loop
    s_lshl_b32 s26, s2, 2
    s_add_u32 s26, s26, s10
    s_xor_b32 s27, s26, 4
    s_lshl_b32 s31, s26, 12
    s_add_u32 s31, s31, 0x2000000
    s_lshl_b32 s32, s27, 12
    s_add_u32 s32, s32, 0x2000000
    s_lshl_b32 s35, s2, 11
    s_lshl_b32 s36, s10, 7
    s_add_u32 s35, s35, s36
    s_add_u32 s35, s35, 0xd00400
    s_xor_b32 s36, s35, 0x800
    v_lshlrev_b32 v14, 4, v0
    s_cmp_eq_u32 s15, 0
    s_cbranch_scc1 Lsequen_m_send_hi
    v_cvt_pk_bf16_f32 v128, v16, v17
    v_cvt_pk_bf16_f32 v129, v18, v19
    v_cvt_pk_bf16_f32 v130, v20, v21
    v_cvt_pk_bf16_f32 v131, v22, v23
    buffer_store_dwordx4 v[128:131], v14, s[20:23], s31 offen offset:0 sc1
    v_cvt_pk_bf16_f32 v132, v32, v33
    v_cvt_pk_bf16_f32 v133, v34, v35
    v_cvt_pk_bf16_f32 v134, v36, v37
    v_cvt_pk_bf16_f32 v135, v38, v39
    buffer_store_dwordx4 v[132:135], v14, s[20:23], s31 offen offset:1024 sc1
    v_cvt_pk_bf16_f32 v136, v48, v49
    v_cvt_pk_bf16_f32 v137, v50, v51
    v_cvt_pk_bf16_f32 v138, v52, v53
    v_cvt_pk_bf16_f32 v139, v54, v55
    buffer_store_dwordx4 v[136:139], v14, s[20:23], s31 offen offset:2048 sc1
    v_cvt_pk_bf16_f32 v140, v64, v65
    v_cvt_pk_bf16_f32 v141, v66, v67
    v_cvt_pk_bf16_f32 v142, v68, v69
    v_cvt_pk_bf16_f32 v143, v70, v71
    buffer_store_dwordx4 v[140:143], v14, s[20:23], s31 offen offset:3072 sc1
    v_mov_b32 v16, v24
    v_mov_b32 v17, v25
    v_mov_b32 v18, v26
    v_mov_b32 v19, v27
    v_mov_b32 v20, v28
    v_mov_b32 v21, v29
    v_mov_b32 v22, v30
    v_mov_b32 v23, v31
    v_mov_b32 v32, v40
    v_mov_b32 v33, v41
    v_mov_b32 v34, v42
    v_mov_b32 v35, v43
    v_mov_b32 v36, v44
    v_mov_b32 v37, v45
    v_mov_b32 v38, v46
    v_mov_b32 v39, v47
    v_mov_b32 v48, v56
    v_mov_b32 v49, v57
    v_mov_b32 v50, v58
    v_mov_b32 v51, v59
    v_mov_b32 v52, v60
    v_mov_b32 v53, v61
    v_mov_b32 v54, v62
    v_mov_b32 v55, v63
    v_mov_b32 v64, v72
    v_mov_b32 v65, v73
    v_mov_b32 v66, v74
    v_mov_b32 v67, v75
    v_mov_b32 v68, v76
    v_mov_b32 v69, v77
    v_mov_b32 v70, v78
    v_mov_b32 v71, v79
    s_branch Lsequen_m_sent
Lsequen_m_send_hi:
    v_cvt_pk_bf16_f32 v128, v24, v25
    v_cvt_pk_bf16_f32 v129, v26, v27
    v_cvt_pk_bf16_f32 v130, v28, v29
    v_cvt_pk_bf16_f32 v131, v30, v31
    buffer_store_dwordx4 v[128:131], v14, s[20:23], s31 offen offset:0 sc1
    v_cvt_pk_bf16_f32 v132, v40, v41
    v_cvt_pk_bf16_f32 v133, v42, v43
    v_cvt_pk_bf16_f32 v134, v44, v45
    v_cvt_pk_bf16_f32 v135, v46, v47
    buffer_store_dwordx4 v[132:135], v14, s[20:23], s31 offen offset:1024 sc1
    v_cvt_pk_bf16_f32 v136, v56, v57
    v_cvt_pk_bf16_f32 v137, v58, v59
    v_cvt_pk_bf16_f32 v138, v60, v61
    v_cvt_pk_bf16_f32 v139, v62, v63
    buffer_store_dwordx4 v[136:139], v14, s[20:23], s31 offen offset:2048 sc1
    v_cvt_pk_bf16_f32 v140, v72, v73
    v_cvt_pk_bf16_f32 v141, v74, v75
    v_cvt_pk_bf16_f32 v142, v76, v77
    v_cvt_pk_bf16_f32 v143, v78, v79
    buffer_store_dwordx4 v[140:143], v14, s[20:23], s31 offen offset:3072 sc1
Lsequen_m_sent:
    v_lshlrev_b32 v13, 7, v7
    v_lshl_add_u32 v13, v4, 3, v13
    s_lshl_b32 s26, s25, 13
    s_add_u32 s26, s26, 131072
    v_add_u32 v13, s26, v13
    s_lshl_b32 s26, s24, 1
    s_add_u32 s27, s26, 0
    v_xor_b32 v15, s27, v6
    v_lshl_add_u32 v8, v15, 5, v13
    s_add_u32 s27, s26, 1
    v_xor_b32 v15, s27, v6
    v_lshl_add_u32 v9, v15, 5, v13
    s_waitcnt lgkmcnt(0)
    ds_read_b64_tr_b16 v[80:81], v8 offset:0
    ds_read_b64_tr_b16 v[82:83], v9 offset:0
    ds_read_b64_tr_b16 v[84:85], v8 offset:2048
    ds_read_b64_tr_b16 v[86:87], v9 offset:2048
    ds_read_b64_tr_b16 v[88:89], v8 offset:4096
    ds_read_b64_tr_b16 v[90:91], v9 offset:4096
    ds_read_b64_tr_b16 v[92:93], v8 offset:6144
    ds_read_b64_tr_b16 v[94:95], v9 offset:6144
    v_and_b32 v10, 15, v0
    v_lshrrev_b32 v11, 1, v2
    v_and_b32 v12, 7, v10
    v_xor_b32 v11, v11, v12
    v_lshlrev_b32 v11, 4, v11
    v_lshl_add_u32 v11, v10, 7, v11
    v_and_b32 v12, 1, v2
    v_lshl_add_u32 v11, v12, 3, v11
    s_lshl_b32 s26, s10, 12
    v_add_u32 v3, s26, v11
    v_xor_b32 v4, 32, v3
    v_xor_b32 v5, 64, v3
    v_xor_b32 v6, 96, v3
    v_lshrrev_b32 v10, 3, v0
    v_and_b32 v11, 7, v0
    v_xor_b32 v12, v11, v10
    v_lshlrev_b32 v12, 4, v12
    v_lshl_add_u32 v12, v10, 7, v12
    v_add_u32 v7, s26, v12
    v_lshlrev_b32 v10, 11, v10
    v_lshl_add_u32 v10, v11, 4, v10
    s_lshl_b32 s26, s13, 7
    s_lshl_b32 s27, s24, 5
    s_add_u32 s26, s26, s27
    s_lshl_b32 s27, s15, 6
    s_add_u32 s26, s26, s27
    s_lshl_b32 s26, s26, 11
    s_lshl_b32 s27, s53, 8
    s_add_u32 s26, s26, s27
    s_lshl_b32 s27, s25, 7
    s_add_u32 s48, s26, s27
    s_add_u32 s49, s48, 16384
    s_add_u32 s50, s48, 32768
    s_add_u32 s51, s48, 49152
    s_mov_b32 s37, 0xffff0000
    s_waitcnt lgkmcnt(0)
    v_lshlrev_b32 v112, 16, v80
    v_and_b32 v113, s37, v80
    v_lshlrev_b32 v114, 16, v81
    v_and_b32 v115, s37, v81
    v_pk_add_f32 v[16:17], v[16:17], v[112:113]
    v_pk_add_f32 v[18:19], v[18:19], v[114:115]
    v_lshlrev_b32 v116, 16, v82
    v_and_b32 v117, s37, v82
    v_lshlrev_b32 v118, 16, v83
    v_and_b32 v119, s37, v83
    v_pk_add_f32 v[20:21], v[20:21], v[116:117]
    v_pk_add_f32 v[22:23], v[22:23], v[118:119]
    v_lshlrev_b32 v112, 16, v84
    v_and_b32 v113, s37, v84
    v_lshlrev_b32 v114, 16, v85
    v_and_b32 v115, s37, v85
    v_pk_add_f32 v[32:33], v[32:33], v[112:113]
    v_pk_add_f32 v[34:35], v[34:35], v[114:115]
    v_lshlrev_b32 v116, 16, v86
    v_and_b32 v117, s37, v86
    v_lshlrev_b32 v118, 16, v87
    v_and_b32 v119, s37, v87
    v_pk_add_f32 v[36:37], v[36:37], v[116:117]
    v_pk_add_f32 v[38:39], v[38:39], v[118:119]
    v_lshlrev_b32 v112, 16, v88
    v_and_b32 v113, s37, v88
    v_lshlrev_b32 v114, 16, v89
    v_and_b32 v115, s37, v89
    v_pk_add_f32 v[48:49], v[48:49], v[112:113]
    v_pk_add_f32 v[50:51], v[50:51], v[114:115]
    v_lshlrev_b32 v116, 16, v90
    v_and_b32 v117, s37, v90
    v_lshlrev_b32 v118, 16, v91
    v_and_b32 v119, s37, v91
    v_pk_add_f32 v[52:53], v[52:53], v[116:117]
    v_pk_add_f32 v[54:55], v[54:55], v[118:119]
    v_lshlrev_b32 v112, 16, v92
    v_and_b32 v113, s37, v92
    v_lshlrev_b32 v114, 16, v93
    v_and_b32 v115, s37, v93
    v_pk_add_f32 v[64:65], v[64:65], v[112:113]
    v_pk_add_f32 v[66:67], v[66:67], v[114:115]
    v_lshlrev_b32 v116, 16, v94
    v_and_b32 v117, s37, v94
    v_lshlrev_b32 v118, 16, v95
    v_and_b32 v119, s37, v95
    v_pk_add_f32 v[68:69], v[68:69], v[116:117]
    v_pk_add_f32 v[70:71], v[70:71], v[118:119]
    v_mov_b32 v15, 0
    s_waitcnt vmcnt(0)
    s_mov_b64 exec, 1
    buffer_store_dwordx2 v[216:217], v15, s[20:23], s35 offen sc1
    s_mov_b32 s38, 0
Lsequen_m_poll:
    buffer_load_dwordx2 v[218:219], v15, s[20:23], s36 offen sc1
    s_add_u32 s38, s38, 1
    s_cmp_gt_u32 s38, 0x200000
    s_cbranch_scc1 Lsequen_m_polled
    s_waitcnt vmcnt(0)
    v_cmp_ne_u64 vcc, v[218:219], v[216:217]
    s_cbranch_vccnz Lsequen_m_poll
Lsequen_m_polled:
    s_mov_b64 exec, -1
    buffer_load_dwordx4 v[96:99], v14, s[20:23], s32 offen offset:0 sc1
    buffer_load_dwordx4 v[100:103], v14, s[20:23], s32 offen offset:1024 sc1
    buffer_load_dwordx4 v[104:107], v14, s[20:23], s32 offen offset:2048 sc1
    buffer_load_dwordx4 v[108:111], v14, s[20:23], s32 offen offset:3072 sc1
    s_waitcnt vmcnt(3)
    v_lshlrev_b32 v112, 16, v96
    v_and_b32 v113, s37, v96
    v_lshlrev_b32 v114, 16, v97
    v_and_b32 v115, s37, v97
    v_pk_add_f32 v[16:17], v[16:17], v[112:113]
    v_pk_add_f32 v[18:19], v[18:19], v[114:115]
    v_cvt_pk_bf16_f32 v80, v16, v17
    v_cvt_pk_bf16_f32 v81, v18, v19
    ds_write_b64 v3, v[80:81] offset:0
    v_lshlrev_b32 v116, 16, v98
    v_and_b32 v117, s37, v98
    v_lshlrev_b32 v118, 16, v99
    v_and_b32 v119, s37, v99
    v_pk_add_f32 v[20:21], v[20:21], v[116:117]
    v_pk_add_f32 v[22:23], v[22:23], v[118:119]
    v_cvt_pk_bf16_f32 v82, v20, v21
    v_cvt_pk_bf16_f32 v83, v22, v23
    ds_write_b64 v3, v[82:83] offset:2048
    s_waitcnt vmcnt(2)
    v_lshlrev_b32 v112, 16, v100
    v_and_b32 v113, s37, v100
    v_lshlrev_b32 v114, 16, v101
    v_and_b32 v115, s37, v101
    v_pk_add_f32 v[32:33], v[32:33], v[112:113]
    v_pk_add_f32 v[34:35], v[34:35], v[114:115]
    v_cvt_pk_bf16_f32 v84, v32, v33
    v_cvt_pk_bf16_f32 v85, v34, v35
    ds_write_b64 v4, v[84:85] offset:0
    v_lshlrev_b32 v116, 16, v102
    v_and_b32 v117, s37, v102
    v_lshlrev_b32 v118, 16, v103
    v_and_b32 v119, s37, v103
    v_pk_add_f32 v[36:37], v[36:37], v[116:117]
    v_pk_add_f32 v[38:39], v[38:39], v[118:119]
    v_cvt_pk_bf16_f32 v86, v36, v37
    v_cvt_pk_bf16_f32 v87, v38, v39
    ds_write_b64 v4, v[86:87] offset:2048
    s_waitcnt vmcnt(1)
    v_lshlrev_b32 v112, 16, v104
    v_and_b32 v113, s37, v104
    v_lshlrev_b32 v114, 16, v105
    v_and_b32 v115, s37, v105
    v_pk_add_f32 v[48:49], v[48:49], v[112:113]
    v_pk_add_f32 v[50:51], v[50:51], v[114:115]
    v_cvt_pk_bf16_f32 v88, v48, v49
    v_cvt_pk_bf16_f32 v89, v50, v51
    ds_write_b64 v5, v[88:89] offset:0
    v_lshlrev_b32 v116, 16, v106
    v_and_b32 v117, s37, v106
    v_lshlrev_b32 v118, 16, v107
    v_and_b32 v119, s37, v107
    v_pk_add_f32 v[52:53], v[52:53], v[116:117]
    v_pk_add_f32 v[54:55], v[54:55], v[118:119]
    v_cvt_pk_bf16_f32 v90, v52, v53
    v_cvt_pk_bf16_f32 v91, v54, v55
    ds_write_b64 v5, v[90:91] offset:2048
    s_waitcnt vmcnt(0)
    v_lshlrev_b32 v112, 16, v108
    v_and_b32 v113, s37, v108
    v_lshlrev_b32 v114, 16, v109
    v_and_b32 v115, s37, v109
    v_pk_add_f32 v[64:65], v[64:65], v[112:113]
    v_pk_add_f32 v[66:67], v[66:67], v[114:115]
    v_cvt_pk_bf16_f32 v92, v64, v65
    v_cvt_pk_bf16_f32 v93, v66, v67
    ds_write_b64 v6, v[92:93] offset:0
    v_lshlrev_b32 v116, 16, v110
    v_and_b32 v117, s37, v110
    v_lshlrev_b32 v118, 16, v111
    v_and_b32 v119, s37, v111
    v_pk_add_f32 v[68:69], v[68:69], v[116:117]
    v_pk_add_f32 v[70:71], v[70:71], v[118:119]
    v_cvt_pk_bf16_f32 v94, v68, v69
    v_cvt_pk_bf16_f32 v95, v70, v71
    ds_write_b64 v6, v[94:95] offset:2048
    s_waitcnt lgkmcnt(0)
    ds_read_b128 v[96:99], v7 offset:0
    ds_read_b128 v[100:103], v7 offset:1024
    ds_read_b128 v[104:107], v7 offset:2048
    ds_read_b128 v[108:111], v7 offset:3072
    s_waitcnt lgkmcnt(3)
    buffer_store_dwordx4 v[96:99], v10, s[44:47], s48 offen
    s_waitcnt lgkmcnt(2)
    buffer_store_dwordx4 v[100:103], v10, s[44:47], s49 offen
    s_waitcnt lgkmcnt(1)
    buffer_store_dwordx4 v[104:107], v10, s[44:47], s50 offen
    s_waitcnt lgkmcnt(0)
    buffer_store_dwordx4 v[108:111], v10, s[44:47], s51 offen
    s_add_u32 s26, s2, s10
    s_cmp_eq_u32 s26, 0
    s_cbranch_scc0 Lsequen_m_fin
    s_load_dwordx2 s[60:61], s[0:1], 80
    v_mov_b32 v2, 0
    v_mov_b32 v3, 0
    s_waitcnt lgkmcnt(0)
    s_mov_b32 s60, s60
    s_and_b32 s61, s61, 0xffff
    s_mov_b32 s62, 0x100
    s_mov_b32 s63, 0x20000
    s_mov_b64 exec, 1
    buffer_store_dwordx2 v[2:3], v2, s[60:63], 0 offen sc1
Lsequen_m_fin:
    s_endpgm
Lmlp_loader:
    s_load_dwordx4 s[4:7], s[0:1], 56
    s_load_dwordx2 s[8:9], s[0:1], 88
    s_load_dwordx2 s[56:57], s[0:1], 72
    s_mov_b32 s10, s60
    s_mov_b32 s55, s38
    s_and_b32 s11, s2, 7
    s_lshr_b32 s12, s2, 3
    s_lshr_b32 s13, s11, 1
    s_lshl_b32 s13, s13, 2
    s_and_b32 s14, s12, 3
    s_add_u32 s13, s13, s14
    s_and_b32 s15, s11, 1
    s_lshr_b32 s53, s12, 2
    s_lshl_b32 s14, s15, 3
    s_add_u32 s14, s14, s53
    v_lshrrev_b32 v2, 4, v0
    v_mov_b32 v216, s98
    v_mov_b32 v217, s99
    s_sub_u32 s24, s10, 4
    s_lshl_b32 s47, s24, 16
    s_lshl_b32 s26, s13, 8
    s_add_u32 s47, s47, s26
    s_add_u32 s47, s47, 0x800000
    s_mul_i32 s48, s24, 114688
    s_mul_i32 s27, s14, 448
    s_add_u32 s48, s48, s27
    s_add_u32 s36, s14, s13
    s_and_b32 s36, s36, 15
    s_mov_b32 s49, 0
    s_lshl_b32 s25, s36, 18
    s_add_u32 s25, s25, s47
    s_mul_i32 s26, s36, 458752
    s_add_u32 s26, s26, s48
    s_lshl_b32 s27, s24, 12
    s_mul_i32 s28, s24, 7168
    s_add_u32 s28, s28, 16384
    v_bfe_u32 v9, v0, 1, 3
    v_and_b32 v10, 1, v0
    v_lshlrev_b32 v10, 4, v10
    v_lshl_add_u32 v10, v2, 12, v10
    v_xor_b32 v9, v9, v2
    v_lshl_add_u32 v16, v9, 5, v10
    v_lshl_add_u32 v17, v9, 5, v10
    v_add_u32 v17, 15360, v17
    v_xor_b32 v9, 4, v9
    v_lshl_add_u32 v18, v9, 5, v10
    v_add_u32 v18, 30720, v18
    v_lshl_add_u32 v19, v9, 5, v10
    v_add_u32 v19, 46080, v19
    v_add_u32 v9, 0, v0
    v_mul_u32_u24 v10, 9363, v9
    v_lshrrev_b32 v10, 18, v10
    v_mul_u32_u24 v11, 28, v10
    v_sub_u32 v11, v9, v11
    v_lshrrev_b32 v12, 2, v10
    v_and_b32 v12, 2, v12
    v_xor_b32 v11, v11, v12
    v_mul_u32_u24 v12, 7168, v10
    v_lshl_add_u32 v12, v11, 4, v12
    v_add_u32 v20, 0, v12
    v_add_u32 v9, 64, v0
    v_mul_u32_u24 v10, 9363, v9
    v_lshrrev_b32 v10, 18, v10
    v_mul_u32_u24 v11, 28, v10
    v_sub_u32 v11, v9, v11
    v_lshrrev_b32 v12, 2, v10
    v_and_b32 v12, 2, v12
    v_xor_b32 v11, v11, v12
    v_mul_u32_u24 v12, 7168, v10
    v_lshl_add_u32 v12, v11, 4, v12
    v_add_u32 v21, -1024, v12
    v_add_u32 v9, 128, v0
    v_mul_u32_u24 v10, 9363, v9
    v_lshrrev_b32 v10, 18, v10
    v_mul_u32_u24 v11, 28, v10
    v_sub_u32 v11, v9, v11
    v_lshrrev_b32 v12, 2, v10
    v_and_b32 v12, 2, v12
    v_xor_b32 v11, v11, v12
    v_mul_u32_u24 v12, 7168, v10
    v_lshl_add_u32 v12, v11, 4, v12
    v_add_u32 v22, -2048, v12
    v_add_u32 v9, 192, v0
    v_mul_u32_u24 v10, 9363, v9
    v_lshrrev_b32 v10, 18, v10
    v_mul_u32_u24 v11, 28, v10
    v_sub_u32 v11, v9, v11
    v_lshrrev_b32 v12, 2, v10
    v_and_b32 v12, 2, v12
    v_xor_b32 v11, v11, v12
    v_mul_u32_u24 v12, 7168, v10
    v_lshl_add_u32 v12, v11, 4, v12
    v_add_u32 v23, -3072, v12
    v_add_u32 v9, 256, v0
    v_mul_u32_u24 v10, 9363, v9
    v_lshrrev_b32 v10, 18, v10
    v_mul_u32_u24 v11, 28, v10
    v_sub_u32 v11, v9, v11
    v_lshrrev_b32 v12, 2, v10
    v_and_b32 v12, 2, v12
    v_xor_b32 v11, v11, v12
    v_mul_u32_u24 v12, 7168, v10
    v_lshl_add_u32 v12, v11, 4, v12
    v_add_u32 v24, 0, v12
    v_add_u32 v9, 320, v0
    v_mul_u32_u24 v10, 9363, v9
    v_lshrrev_b32 v10, 18, v10
    v_mul_u32_u24 v11, 28, v10
    v_sub_u32 v11, v9, v11
    v_lshrrev_b32 v12, 2, v10
    v_and_b32 v12, 2, v12
    v_xor_b32 v11, v11, v12
    v_mul_u32_u24 v12, 7168, v10
    v_lshl_add_u32 v12, v11, 4, v12
    v_add_u32 v25, -1024, v12
    v_add_u32 v9, 384, v0
    v_mul_u32_u24 v10, 9363, v9
    v_lshrrev_b32 v10, 18, v10
    v_mul_u32_u24 v11, 28, v10
    v_sub_u32 v11, v9, v11
    v_lshrrev_b32 v12, 2, v10
    v_and_b32 v12, 2, v12
    v_xor_b32 v11, v11, v12
    v_mul_u32_u24 v12, 7168, v10
    v_lshl_add_u32 v12, v11, 4, v12
    v_add_u32 v26, -2048, v12
    s_waitcnt lgkmcnt(0)
    s_mov_b32 s20, s8
    s_and_b32 s21, s9, 0xffff
    s_mov_b32 s22, 0x10000000
    s_mov_b32 s23, 0x20000
    s_mov_b32 s16, s4
    s_and_b32 s17, s5, 0xffff
    s_mov_b32 s18, 0x700000
    s_mov_b32 s19, 0x20000
    s_cmp_ge_u32 s24, 2
    s_cbranch_scc1 Lsequen_m_now0
    s_add_u32 m0, s28, 90112
    s_nop 0
    buffer_load_dwordx4 v20, s[16:19], s26 offen offset:0 lds
    buffer_load_dwordx4 v21, s[16:19], s26 offen offset:1024 lds
    buffer_load_dwordx4 v22, s[16:19], s26 offen offset:2048 lds
    buffer_load_dwordx4 v23, s[16:19], s26 offen offset:3072 lds
    s_add_u32 m0, s28, 94208
    s_nop 0
    buffer_load_dwordx4 v24, s[16:19], s26 offen offset:0 lds
    buffer_load_dwordx4 v25, s[16:19], s26 offen offset:1024 lds
    buffer_load_dwordx4 v26, s[16:19], s26 offen offset:2048 lds
    s_add_u32 s26, s26, 229376
    s_add_u32 m0, s28, 104448
    s_nop 0
    buffer_load_dwordx4 v20, s[16:19], s26 offen offset:0 lds
    buffer_load_dwordx4 v21, s[16:19], s26 offen offset:1024 lds
    buffer_load_dwordx4 v22, s[16:19], s26 offen offset:2048 lds
    buffer_load_dwordx4 v23, s[16:19], s26 offen offset:3072 lds
    s_add_u32 m0, s28, 108544
    s_nop 0
    buffer_load_dwordx4 v24, s[16:19], s26 offen offset:0 lds
    buffer_load_dwordx4 v25, s[16:19], s26 offen offset:1024 lds
    buffer_load_dwordx4 v26, s[16:19], s26 offen offset:2048 lds
Lsequen_m_now0:
    s_mov_b32 s50, s25
    s_mov_b32 s62, s36
    s_add_u32 s49, s49, 1
    s_add_u32 s37, s36, 1
    s_and_b32 s37, s37, 3
    s_and_b32 s36, s36, 12
    s_or_b32 s36, s36, s37
    s_and_b32 s37, s49, 3
    s_cmp_eq_u32 s37, 0
    s_cselect_b32 s37, 4, 0
    s_add_u32 s36, s36, s37
    s_and_b32 s36, s36, 15
    s_lshl_b32 s25, s36, 18
    s_add_u32 s25, s25, s47
    s_mul_i32 s26, s36, 458752
    s_add_u32 s26, s26, s48
    v_lshrrev_b32 v9, 3, v0
    v_lshlrev_b32 v9, 11, v9
    v_bfe_u32 v10, v0, 2, 1
    v_lshl_add_u32 v9, v10, 18, v9
    v_and_b32 v10, 3, v0
    v_lshl_add_u32 v38, v10, 14, v9
    s_lshl_b32 s52, s24, 16
    s_add_u32 s52, s52, 0xd00280
    s_mov_b64 s[58:59], 0
    s_mov_b32 s39, 0
    v_mov_b32 v35, 153712
Lsequen_m_waitF:
    s_sleep 1
    ds_read_b32 v34, v35
    s_waitcnt lgkmcnt(0)
    v_cmp_gt_u32 vcc, 4, v34
    s_cbranch_vccnz Lsequen_m_waitF
    v_mov_b32 v100, 0
    s_lshl_b32 s60, s62, 2
    s_lshl_b64 s[66:67], 15, s60
Lsequen_m_need0:
    s_lshl_b32 s60, s62, 2
    s_lshr_b64 s[60:61], s[58:59], s60
    s_and_b32 s60, s60, 15
    s_cmp_eq_u32 s60, 15
    s_cbranch_scc1 Lsequen_m_have0
    s_mov_b64 exec, s[66:67]
    buffer_load_dwordx2 v[100:101], v38, s[20:23], s52 offen sc1
    s_mov_b64 exec, -1
    s_add_u32 s39, s39, 1
    s_cmp_gt_u32 s39, 0x100000
    s_cbranch_scc1 Lsequen_m_have0
    s_waitcnt vmcnt(0)
    v_cmp_eq_u64 vcc, v[100:101], v[216:217]
    s_or_b64 s[58:59], s[58:59], vcc
    s_branch Lsequen_m_need0
Lsequen_m_have0:
    s_add_u32 m0, s27, 90112
    s_nop 0
    buffer_load_dwordx4 v16, s[20:23], s50 offen offset:0 sc1 lds
    buffer_load_dwordx4 v17, s[20:23], s50 offen offset:1024 sc1 lds
    buffer_load_dwordx4 v18, s[20:23], s50 offen offset:2048 sc1 lds
    buffer_load_dwordx4 v19, s[20:23], s50 offen offset:3072 sc1 lds
    s_add_u32 m0, s28, 0
    s_nop 0
    buffer_load_dwordx4 v20, s[16:19], s26 offen offset:0 lds
    buffer_load_dwordx4 v21, s[16:19], s26 offen offset:1024 lds
    buffer_load_dwordx4 v22, s[16:19], s26 offen offset:2048 lds
    buffer_load_dwordx4 v23, s[16:19], s26 offen offset:3072 lds
    s_add_u32 m0, s28, 4096
    s_nop 0
    buffer_load_dwordx4 v24, s[16:19], s26 offen offset:0 lds
    buffer_load_dwordx4 v25, s[16:19], s26 offen offset:1024 lds
    buffer_load_dwordx4 v26, s[16:19], s26 offen offset:2048 lds
    s_waitcnt vmcnt(7)
    s_barrier
    s_lshl_b32 s60, s36, 2
    s_lshl_b64 s[66:67], 15, s60
Lsequen_m_need1:
    s_lshl_b32 s60, s36, 2
    s_lshr_b64 s[60:61], s[58:59], s60
    s_and_b32 s60, s60, 15
    s_cmp_eq_u32 s60, 15
    s_cbranch_scc1 Lsequen_m_have1
    s_mov_b64 exec, s[66:67]
    buffer_load_dwordx2 v[100:101], v38, s[20:23], s52 offen sc1
    s_mov_b64 exec, -1
    s_add_u32 s39, s39, 1
    s_cmp_gt_u32 s39, 0x100000
    s_cbranch_scc1 Lsequen_m_have1
    s_waitcnt vmcnt(0)
    v_cmp_eq_u64 vcc, v[100:101], v[216:217]
    s_or_b64 s[58:59], s[58:59], vcc
    s_branch Lsequen_m_need1
Lsequen_m_have1:
    s_mov_b32 m0, s27
    s_nop 0
    buffer_load_dwordx4 v16, s[20:23], s25 offen offset:0 sc1 lds
    buffer_load_dwordx4 v17, s[20:23], s25 offen offset:1024 sc1 lds
    buffer_load_dwordx4 v18, s[20:23], s25 offen offset:2048 sc1 lds
    buffer_load_dwordx4 v19, s[20:23], s25 offen offset:3072 sc1 lds
    s_add_u32 s49, s49, 1
    s_add_u32 s37, s36, 1
    s_and_b32 s37, s37, 3
    s_and_b32 s36, s36, 12
    s_or_b32 s36, s36, s37
    s_and_b32 s37, s49, 3
    s_cmp_eq_u32 s37, 0
    s_cselect_b32 s37, 4, 0
    s_add_u32 s36, s36, s37
    s_and_b32 s36, s36, 15
    s_lshl_b32 s25, s36, 18
    s_add_u32 s25, s25, s47
    s_mul_i32 s26, s36, 458752
    s_add_u32 s26, s26, s48
    s_mov_b32 s29, 45056
    s_mov_b32 s40, s6
    s_and_b32 s41, s7, 0xffff
    s_mov_b32 s42, 0x700000
    s_mov_b32 s43, 0x20000
    s_lshl_b32 s63, s2, 2
    s_add_u32 s63, s63, s24
    s_mul_i32 s63, s63, 7168
    v_lshlrev_b32 v39, 7, v0
Lsequen_m_need2:
    s_lshl_b32 s60, s36, 2
    s_lshr_b64 s[60:61], s[58:59], s60
    s_and_b32 s60, s60, 15
    s_cmp_eq_u32 s60, 15
    s_cbranch_scc1 Lsequen_m_have2
    buffer_load_dwordx2 v[100:101], v38, s[20:23], s52 offen sc1
    s_add_u32 s39, s39, 1
    s_cmp_gt_u32 s39, 0x100000
    s_cbranch_scc1 Lsequen_m_have2
    s_waitcnt vmcnt(0)
    v_cmp_eq_u64 vcc, v[100:101], v[216:217]
    s_or_b64 s[58:59], s[58:59], vcc
    s_branch Lsequen_m_need2
Lsequen_m_have2:
    s_add_u32 m0, s27, s29
    s_add_u32 s30, s28, s29
    buffer_load_dwordx4 v16, s[20:23], s25 offen offset:0 sc1 lds
    buffer_load_dwordx4 v17, s[20:23], s25 offen offset:1024 sc1 lds
    buffer_load_dwordx4 v18, s[20:23], s25 offen offset:2048 sc1 lds
    buffer_load_dwordx4 v19, s[20:23], s25 offen offset:3072 sc1 lds
    s_mov_b32 m0, s30
    s_nop 0
    buffer_load_dwordx4 v20, s[16:19], s26 offen offset:0 lds
    buffer_load_dwordx4 v21, s[16:19], s26 offen offset:1024 lds
    buffer_load_dwordx4 v22, s[16:19], s26 offen offset:2048 lds
    buffer_load_dwordx4 v23, s[16:19], s26 offen offset:3072 lds
    s_add_u32 m0, s30, 4096
    s_add_u32 s29, s29, 45056
    buffer_load_dwordx4 v24, s[16:19], s26 offen offset:0 lds
    buffer_load_dwordx4 v25, s[16:19], s26 offen offset:1024 lds
    buffer_load_dwordx4 v26, s[16:19], s26 offen offset:2048 lds
    s_cmp_eq_u32 s29, 135168
    s_cselect_b32 s29, 0, s29
    s_add_u32 s49, s49, 1
    s_add_u32 s37, s36, 1
    s_and_b32 s37, s37, 3
    s_and_b32 s36, s36, 12
    s_or_b32 s36, s36, s37
    s_and_b32 s37, s49, 3
    s_cmp_eq_u32 s37, 0
    s_cselect_b32 s37, 4, 0
    s_add_u32 s36, s36, s37
    s_and_b32 s36, s36, 15
    s_lshl_b32 s25, s36, 18
    s_add_u32 s25, s25, s47
    s_mul_i32 s26, s36, 458752
    s_add_u32 s26, s26, s48
    v_bfe_u32 v3, v0, 2, 2
    v_and_b32 v4, 3, v0
    v_and_b32 v5, 1, v2
    v_lshl_or_b32 v6, v5, 2, v3
    v_lshl_add_u32 v7, v2, 3, v3
    v_lshlrev_b32 v8, 8, v7
    v_lshl_add_u32 v8, v4, 3, v8
    s_lshl_b32 s31, s24, 1
    v_xor_b32 v12, s31, v6
    v_lshl_add_u32 v36, v12, 5, v8
    v_add_u32 v36, 90112, v36
    v_xor_b32 v37, 32, v36
    v_mov_b32 v40, 0
    v_mov_b32 v41, 0
    v_mov_b32 v42, 0
    v_mov_b32 v43, 0
    v_mov_b32 v44, 0
    v_mov_b32 v45, 0
    v_mov_b32 v46, 0
    v_mov_b32 v47, 0
    s_mov_b32 s33, 0xffff0000
    ds_read_b64_tr_b16 v[48:49], v36 offset:0
    ds_read_b64_tr_b16 v[50:51], v36 offset:1024
    ds_read_b64_tr_b16 v[52:53], v36 offset:8192
    ds_read_b64_tr_b16 v[54:55], v36 offset:9216
    ds_read_b64_tr_b16 v[56:57], v37 offset:0
    ds_read_b64_tr_b16 v[58:59], v37 offset:1024
    ds_read_b64_tr_b16 v[60:61], v37 offset:8192
    ds_read_b64_tr_b16 v[62:63], v37 offset:9216
    s_waitcnt lgkmcnt(0)
    v_lshlrev_b32 v64, 16, v48
    v_and_b32 v65, s33, v48
    v_lshlrev_b32 v66, 16, v56
    v_and_b32 v67, s33, v56
    v_add_f32 v40, v40, v64
    v_fmac_f32 v44, v64, v64
    v_add_f32 v41, v41, v65
    v_fmac_f32 v45, v65, v65
    v_add_f32 v42, v42, v66
    v_fmac_f32 v46, v66, v66
    v_add_f32 v43, v43, v67
    v_fmac_f32 v47, v67, v67
    v_lshlrev_b32 v64, 16, v49
    v_and_b32 v65, s33, v49
    v_lshlrev_b32 v66, 16, v57
    v_and_b32 v67, s33, v57
    v_add_f32 v40, v40, v64
    v_fmac_f32 v44, v64, v64
    v_add_f32 v41, v41, v65
    v_fmac_f32 v45, v65, v65
    v_add_f32 v42, v42, v66
    v_fmac_f32 v46, v66, v66
    v_add_f32 v43, v43, v67
    v_fmac_f32 v47, v67, v67
    v_lshlrev_b32 v64, 16, v50
    v_and_b32 v65, s33, v50
    v_lshlrev_b32 v66, 16, v58
    v_and_b32 v67, s33, v58
    v_add_f32 v40, v40, v64
    v_fmac_f32 v44, v64, v64
    v_add_f32 v41, v41, v65
    v_fmac_f32 v45, v65, v65
    v_add_f32 v42, v42, v66
    v_fmac_f32 v46, v66, v66
    v_add_f32 v43, v43, v67
    v_fmac_f32 v47, v67, v67
    v_lshlrev_b32 v64, 16, v51
    v_and_b32 v65, s33, v51
    v_lshlrev_b32 v66, 16, v59
    v_and_b32 v67, s33, v59
    v_add_f32 v40, v40, v64
    v_fmac_f32 v44, v64, v64
    v_add_f32 v41, v41, v65
    v_fmac_f32 v45, v65, v65
    v_add_f32 v42, v42, v66
    v_fmac_f32 v46, v66, v66
    v_add_f32 v43, v43, v67
    v_fmac_f32 v47, v67, v67
    v_lshlrev_b32 v64, 16, v52
    v_and_b32 v65, s33, v52
    v_lshlrev_b32 v66, 16, v60
    v_and_b32 v67, s33, v60
    v_add_f32 v40, v40, v64
    v_fmac_f32 v44, v64, v64
    v_add_f32 v41, v41, v65
    v_fmac_f32 v45, v65, v65
    v_add_f32 v42, v42, v66
    v_fmac_f32 v46, v66, v66
    v_add_f32 v43, v43, v67
    v_fmac_f32 v47, v67, v67
    v_lshlrev_b32 v64, 16, v53
    v_and_b32 v65, s33, v53
    v_lshlrev_b32 v66, 16, v61
    v_and_b32 v67, s33, v61
    v_add_f32 v40, v40, v64
    v_fmac_f32 v44, v64, v64
    v_add_f32 v41, v41, v65
    v_fmac_f32 v45, v65, v65
    v_add_f32 v42, v42, v66
    v_fmac_f32 v46, v66, v66
    v_add_f32 v43, v43, v67
    v_fmac_f32 v47, v67, v67
    v_lshlrev_b32 v64, 16, v54
    v_and_b32 v65, s33, v54
    v_lshlrev_b32 v66, 16, v62
    v_and_b32 v67, s33, v62
    v_add_f32 v40, v40, v64
    v_fmac_f32 v44, v64, v64
    v_add_f32 v41, v41, v65
    v_fmac_f32 v45, v65, v65
    v_add_f32 v42, v42, v66
    v_fmac_f32 v46, v66, v66
    v_add_f32 v43, v43, v67
    v_fmac_f32 v47, v67, v67
    v_lshlrev_b32 v64, 16, v55
    v_and_b32 v65, s33, v55
    v_lshlrev_b32 v66, 16, v63
    v_and_b32 v67, s33, v63
    v_add_f32 v40, v40, v64
    v_fmac_f32 v44, v64, v64
    v_add_f32 v41, v41, v65
    v_fmac_f32 v45, v65, v65
    v_add_f32 v42, v42, v66
    v_fmac_f32 v46, v66, v66
    v_add_f32 v43, v43, v67
    v_fmac_f32 v47, v67, v67
    v_add_f32 v40, v40, v41
    v_add_f32 v42, v42, v43
    v_add_f32 v44, v44, v45
    v_add_f32 v46, v46, v47
    v_mov_b32 v48, v40
    v_mov_b32 v49, v42
    v_mov_b32 v50, v44
    v_mov_b32 v51, v46
    s_nop 1
    v_permlane32_swap_b32 v40, v48
    v_permlane32_swap_b32 v42, v49
    v_permlane32_swap_b32 v44, v50
    v_permlane32_swap_b32 v46, v51
    s_nop 1
    v_add_f32 v40, v40, v48
    v_add_f32 v42, v42, v49
    v_add_f32 v44, v44, v50
    v_add_f32 v46, v46, v51
    v_mov_b32 v48, v40
    v_mov_b32 v49, v42
    v_mov_b32 v50, v44
    v_mov_b32 v51, v46
    s_nop 1
    v_permlane16_swap_b32 v40, v48
    v_permlane16_swap_b32 v42, v49
    v_permlane16_swap_b32 v44, v50
    v_permlane16_swap_b32 v46, v51
    s_nop 1
    v_add_f32 v40, v40, v48
    v_add_f32 v42, v42, v49
    v_add_f32 v44, v44, v50
    v_add_f32 v46, v46, v51
    v_cmp_gt_u32 vcc, 16, v0
    s_lshl_b32 s31, s13, 15
    s_lshl_b32 s32, s24, 9
    s_add_u32 s31, s31, s32
    s_add_u32 s31, s31, 0xe00000
    s_lshl_b32 s32, s14, 11
    s_add_u32 s32, s32, s31
    v_cndmask_b32 v214, v42, v40, vcc
    v_cndmask_b32 v215, v46, v44, vcc
    v_lshlrev_b32 v9, 4, v0
    s_mov_b64 exec, 0xffffffff
    buffer_store_dwordx4 v[214:217], v9, s[20:23], s32 offen sc1
    s_mov_b64 exec, -1
    v_mul_u32_u24 v12, 448, v7
    v_lshl_add_u32 v12, v4, 3, v12
    s_lshl_b32 s32, s24, 7
    s_add_u32 s32, s32, 106496
    v_add_u32 v12, s32, v12
    v_lshl_add_u32 v13, v5, 5, v12
    v_xor_b32 v14, 1, v5
    v_lshl_add_u32 v14, v14, 5, v12
    ds_read_b64_tr_b16 v[68:69], v13 offset:0
    ds_read_b64_tr_b16 v[70:71], v13 offset:1792
    ds_read_b64_tr_b16 v[72:73], v13 offset:14336
    ds_read_b64_tr_b16 v[74:75], v13 offset:16128
    ds_read_b64_tr_b16 v[76:77], v14 offset:0
    ds_read_b64_tr_b16 v[78:79], v14 offset:1792
    ds_read_b64_tr_b16 v[80:81], v14 offset:14336
    ds_read_b64_tr_b16 v[82:83], v14 offset:16128
    ds_read_b64_tr_b16 v[84:85], v13 offset:64
    ds_read_b64_tr_b16 v[86:87], v13 offset:1856
    ds_read_b64_tr_b16 v[88:89], v13 offset:14400
    ds_read_b64_tr_b16 v[90:91], v13 offset:16192
    s_waitcnt lgkmcnt(8)
    ds_read_b64_tr_b16 v[92:93], v14 offset:64
    ds_read_b64_tr_b16 v[94:95], v14 offset:1856
    ds_read_b64_tr_b16 v[96:97], v14 offset:14400
    ds_read_b64_tr_b16 v[98:99], v14 offset:16192
    v_mov_b32 v40, 0
    v_mov_b32 v41, 0
    v_mov_b32 v42, 0
    v_mov_b32 v43, 0
    v_mov_b32 v44, 0
    v_mov_b32 v45, 0
    v_mov_b32 v46, 0
    v_mov_b32 v47, 0
    s_waitcnt lgkmcnt(0)
    v_lshlrev_b32 v64, 16, v68
    v_and_b32 v65, s33, v68
    v_add_f32 v40, v40, v64
    v_add_f32 v44, v44, v65
    v_lshlrev_b32 v64, 16, v76
    v_and_b32 v65, s33, v76
    v_add_f32 v41, v41, v64
    v_add_f32 v45, v45, v65
    v_lshlrev_b32 v64, 16, v84
    v_and_b32 v65, s33, v84
    v_add_f32 v42, v42, v64
    v_add_f32 v46, v46, v65
    v_lshlrev_b32 v64, 16, v92
    v_and_b32 v65, s33, v92
    v_add_f32 v43, v43, v64
    v_add_f32 v47, v47, v65
    v_lshlrev_b32 v64, 16, v69
    v_and_b32 v65, s33, v69
    v_add_f32 v40, v40, v64
    v_add_f32 v44, v44, v65
    v_lshlrev_b32 v64, 16, v77
    v_and_b32 v65, s33, v77
    v_add_f32 v41, v41, v64
    v_add_f32 v45, v45, v65
    v_lshlrev_b32 v64, 16, v85
    v_and_b32 v65, s33, v85
    v_add_f32 v42, v42, v64
    v_add_f32 v46, v46, v65
    v_lshlrev_b32 v64, 16, v93
    v_and_b32 v65, s33, v93
    v_add_f32 v43, v43, v64
    v_add_f32 v47, v47, v65
    v_lshlrev_b32 v64, 16, v70
    v_and_b32 v65, s33, v70
    v_add_f32 v40, v40, v64
    v_add_f32 v44, v44, v65
    v_lshlrev_b32 v64, 16, v78
    v_and_b32 v65, s33, v78
    v_add_f32 v41, v41, v64
    v_add_f32 v45, v45, v65
    v_lshlrev_b32 v64, 16, v86
    v_and_b32 v65, s33, v86
    v_add_f32 v42, v42, v64
    v_add_f32 v46, v46, v65
    v_lshlrev_b32 v64, 16, v94
    v_and_b32 v65, s33, v94
    v_add_f32 v43, v43, v64
    v_add_f32 v47, v47, v65
    v_lshlrev_b32 v64, 16, v71
    v_and_b32 v65, s33, v71
    v_add_f32 v40, v40, v64
    v_add_f32 v44, v44, v65
    v_lshlrev_b32 v64, 16, v79
    v_and_b32 v65, s33, v79
    v_add_f32 v41, v41, v64
    v_add_f32 v45, v45, v65
    v_lshlrev_b32 v64, 16, v87
    v_and_b32 v65, s33, v87
    v_add_f32 v42, v42, v64
    v_add_f32 v46, v46, v65
    v_lshlrev_b32 v64, 16, v95
    v_and_b32 v65, s33, v95
    v_add_f32 v43, v43, v64
    v_add_f32 v47, v47, v65
    v_lshlrev_b32 v64, 16, v72
    v_and_b32 v65, s33, v72
    v_add_f32 v40, v40, v64
    v_add_f32 v44, v44, v65
    v_lshlrev_b32 v64, 16, v80
    v_and_b32 v65, s33, v80
    v_add_f32 v41, v41, v64
    v_add_f32 v45, v45, v65
    v_lshlrev_b32 v64, 16, v88
    v_and_b32 v65, s33, v88
    v_add_f32 v42, v42, v64
    v_add_f32 v46, v46, v65
    v_lshlrev_b32 v64, 16, v96
    v_and_b32 v65, s33, v96
    v_add_f32 v43, v43, v64
    v_add_f32 v47, v47, v65
    v_lshlrev_b32 v64, 16, v73
    v_and_b32 v65, s33, v73
    v_add_f32 v40, v40, v64
    v_add_f32 v44, v44, v65
    v_lshlrev_b32 v64, 16, v81
    v_and_b32 v65, s33, v81
    v_add_f32 v41, v41, v64
    v_add_f32 v45, v45, v65
    v_lshlrev_b32 v64, 16, v89
    v_and_b32 v65, s33, v89
    v_add_f32 v42, v42, v64
    v_add_f32 v46, v46, v65
    v_lshlrev_b32 v64, 16, v97
    v_and_b32 v65, s33, v97
    v_add_f32 v43, v43, v64
    v_add_f32 v47, v47, v65
    v_lshlrev_b32 v64, 16, v74
    v_and_b32 v65, s33, v74
    v_add_f32 v40, v40, v64
    v_add_f32 v44, v44, v65
    v_lshlrev_b32 v64, 16, v82
    v_and_b32 v65, s33, v82
    v_add_f32 v41, v41, v64
    v_add_f32 v45, v45, v65
    v_lshlrev_b32 v64, 16, v90
    v_and_b32 v65, s33, v90
    v_add_f32 v42, v42, v64
    v_add_f32 v46, v46, v65
    v_lshlrev_b32 v64, 16, v98
    v_and_b32 v65, s33, v98
    v_add_f32 v43, v43, v64
    v_add_f32 v47, v47, v65
    v_lshlrev_b32 v64, 16, v75
    v_and_b32 v65, s33, v75
    v_add_f32 v40, v40, v64
    v_add_f32 v44, v44, v65
    v_lshlrev_b32 v64, 16, v83
    v_and_b32 v65, s33, v83
    v_add_f32 v41, v41, v64
    v_add_f32 v45, v45, v65
    v_lshlrev_b32 v64, 16, v91
    v_and_b32 v65, s33, v91
    v_add_f32 v42, v42, v64
    v_add_f32 v46, v46, v65
    v_lshlrev_b32 v64, 16, v99
    v_and_b32 v65, s33, v99
    v_add_f32 v43, v43, v64
    v_add_f32 v47, v47, v65
    v_add_f32 v40, v40, v44
    v_add_f32 v41, v41, v45
    v_add_f32 v42, v42, v46
    v_add_f32 v43, v43, v47
    v_mov_b32 v48, v40
    v_mov_b32 v49, v41
    v_mov_b32 v50, v42
    v_mov_b32 v51, v43
    s_nop 1
    v_permlane32_swap_b32 v40, v48
    v_permlane32_swap_b32 v41, v49
    v_permlane32_swap_b32 v42, v50
    v_permlane32_swap_b32 v43, v51
    s_nop 1
    v_add_f32 v40, v40, v48
    v_add_f32 v41, v41, v49
    v_add_f32 v42, v42, v50
    v_add_f32 v43, v43, v51
    v_mov_b32 v48, v40
    v_mov_b32 v49, v41
    v_mov_b32 v50, v42
    v_mov_b32 v51, v43
    s_nop 1
    v_permlane16_swap_b32 v40, v48
    v_permlane16_swap_b32 v41, v49
    v_permlane16_swap_b32 v42, v50
    v_permlane16_swap_b32 v43, v51
    s_nop 1
    v_add_f32 v40, v40, v48
    v_add_f32 v41, v41, v49
    v_add_f32 v42, v42, v50
    v_add_f32 v43, v43, v51
    v_cmp_gt_u32 vcc, 16, v0
    s_lshl_b32 s32, s14, 4
    s_add_u32 s32, s32, s13
    s_lshl_b32 s32, s32, 11
    s_lshl_b32 s34, s24, 9
    s_add_u32 s32, s32, s34
    s_add_u32 s32, s32, 0xe80000
    v_cndmask_b32 v214, v42, v40, vcc
    v_cndmask_b32 v215, v43, v41, vcc
    s_mov_b64 exec, 0xffffffff
    buffer_store_dwordx4 v[214:217], v9, s[20:23], s32 offen sc1
    s_mov_b64 exec, -1
    s_mov_b32 s35, 0
Lsequen_m_l1loop:
    s_cmp_eq_u32 s35, 0
    s_cbranch_scc1 Lsequen_m_lw20
    s_cmp_eq_u32 s35, 1
    s_cbranch_scc1 Lsequen_m_lw12
    s_waitcnt vmcnt(11)
Lsequen_m_lw12:
    s_waitcnt vmcnt(13)
Lsequen_m_lw20:
    s_waitcnt vmcnt(13)
    s_barrier
    s_cmp_ge_u32 s35, 13
    s_cbranch_scc1 Lsequen_m_l1done
Lsequen_m_need3:
    s_lshl_b32 s60, s36, 2
    s_lshr_b64 s[60:61], s[58:59], s60
    s_and_b32 s60, s60, 15
    s_cmp_eq_u32 s60, 15
    s_cbranch_scc1 Lsequen_m_have3
    buffer_load_dwordx2 v[100:101], v38, s[20:23], s52 offen sc1
    s_add_u32 s39, s39, 1
    s_cmp_gt_u32 s39, 0x100000
    s_cbranch_scc1 Lsequen_m_have3
    s_waitcnt vmcnt(0)
    v_cmp_eq_u64 vcc, v[100:101], v[216:217]
    s_or_b64 s[58:59], s[58:59], vcc
    s_branch Lsequen_m_need3
Lsequen_m_have3:
    s_add_u32 m0, s27, s29
    s_add_u32 s30, s28, s29
    buffer_load_dwordx4 v16, s[20:23], s25 offen offset:0 sc1 lds
    buffer_load_dwordx4 v17, s[20:23], s25 offen offset:1024 sc1 lds
    buffer_load_dwordx4 v18, s[20:23], s25 offen offset:2048 sc1 lds
    buffer_load_dwordx4 v19, s[20:23], s25 offen offset:3072 sc1 lds
    s_mov_b32 m0, s30
    s_nop 0
    buffer_load_dwordx4 v20, s[16:19], s26 offen offset:0 lds
    buffer_load_dwordx4 v21, s[16:19], s26 offen offset:1024 lds
    buffer_load_dwordx4 v22, s[16:19], s26 offen offset:2048 lds
    buffer_load_dwordx4 v23, s[16:19], s26 offen offset:3072 lds
    s_add_u32 m0, s30, 4096
    s_add_u32 s29, s29, 45056
    buffer_load_dwordx4 v24, s[16:19], s26 offen offset:0 lds
    buffer_load_dwordx4 v25, s[16:19], s26 offen offset:1024 lds
    buffer_load_dwordx4 v26, s[16:19], s26 offen offset:2048 lds
    s_cmp_eq_u32 s29, 135168
    s_cselect_b32 s29, 0, s29
    s_add_u32 s49, s49, 1
    s_add_u32 s37, s36, 1
    s_and_b32 s37, s37, 3
    s_and_b32 s36, s36, 12
    s_or_b32 s36, s36, s37
    s_and_b32 s37, s49, 3
    s_cmp_eq_u32 s37, 0
    s_cselect_b32 s37, 4, 0
    s_add_u32 s36, s36, s37
    s_and_b32 s36, s36, 15
    s_lshl_b32 s25, s36, 18
    s_add_u32 s25, s25, s47
    s_mul_i32 s26, s36, 458752
    s_add_u32 s26, s26, s48
    s_add_u32 s35, s35, 1
    s_branch Lsequen_m_l1loop
Lsequen_m_l1done:
    s_lshl_b32 s33, s14, 15
    s_lshl_b32 s34, s24, 9
    s_add_u32 s33, s33, s34
    s_add_u32 s33, s33, 0xe80000
    v_and_b32 v10, 31, v0
    v_lshlrev_b32 v9, 4, v10
    v_lshrrev_b32 v11, 5, v0
    v_lshl_add_u32 v9, v11, 11, v9
    v_and_b32 v11, 7, v0
    v_lshlrev_b32 v11, 16, v11
    s_and_b32 s34, s2, 31
    s_lshl_b32 s34, s34, 11
    s_add_u32 s50, s34, 0xd00380
    s_add_u32 s51, s34, 0xd00300
    s_mov_b32 s39, 0
Lsequen_m_spoll:
    s_mov_b32 s32, s31
    buffer_load_dwordx4 v[68:71], v9, s[20:23], s32 offen sc1
    s_add_u32 s32, s32, 4096
    buffer_load_dwordx4 v[72:75], v9, s[20:23], s32 offen sc1
    s_add_u32 s32, s32, 4096
    buffer_load_dwordx4 v[76:79], v9, s[20:23], s32 offen sc1
    s_add_u32 s32, s32, 4096
    buffer_load_dwordx4 v[80:83], v9, s[20:23], s32 offen sc1
    s_add_u32 s32, s32, 4096
    buffer_load_dwordx4 v[84:87], v9, s[20:23], s32 offen sc1
    s_add_u32 s32, s32, 4096
    buffer_load_dwordx4 v[88:91], v9, s[20:23], s32 offen sc1
    s_add_u32 s32, s32, 4096
    buffer_load_dwordx4 v[92:95], v9, s[20:23], s32 offen sc1
    s_add_u32 s32, s32, 4096
    buffer_load_dwordx4 v[96:99], v9, s[20:23], s32 offen sc1
    s_add_u32 s32, s32, 4096
    s_mov_b32 s32, s33
    buffer_load_dwordx4 v[100:103], v9, s[20:23], s32 offen sc1
    s_add_u32 s32, s32, 4096
    buffer_load_dwordx4 v[104:107], v9, s[20:23], s32 offen sc1
    s_add_u32 s32, s32, 4096
    buffer_load_dwordx4 v[108:111], v9, s[20:23], s32 offen sc1
    s_add_u32 s32, s32, 4096
    buffer_load_dwordx4 v[112:115], v9, s[20:23], s32 offen sc1
    s_add_u32 s32, s32, 4096
    buffer_load_dwordx4 v[116:119], v9, s[20:23], s32 offen sc1
    s_add_u32 s32, s32, 4096
    buffer_load_dwordx4 v[120:123], v9, s[20:23], s32 offen sc1
    s_add_u32 s32, s32, 4096
    buffer_load_dwordx4 v[124:127], v9, s[20:23], s32 offen sc1
    s_add_u32 s32, s32, 4096
    buffer_load_dwordx4 v[128:131], v9, s[20:23], s32 offen sc1
    s_add_u32 s32, s32, 4096
    buffer_load_dwordx3 v[64:66], v11, s[20:23], s50 offen sc1
    s_add_u32 s39, s39, 1
    s_cmp_gt_u32 s39, 0x100000
    s_cbranch_scc1 Lsequen_m_spolled
    s_waitcnt vmcnt(0)
    v_cmp_ne_u64 s[44:45], v[64:65], v[216:217]
    v_cmp_ne_u64 vcc, v[70:71], v[216:217]
    s_or_b64 s[44:45], s[44:45], vcc
    v_cmp_ne_u64 vcc, v[74:75], v[216:217]
    s_or_b64 s[44:45], s[44:45], vcc
    v_cmp_ne_u64 vcc, v[78:79], v[216:217]
    s_or_b64 s[44:45], s[44:45], vcc
    v_cmp_ne_u64 vcc, v[82:83], v[216:217]
    s_or_b64 s[44:45], s[44:45], vcc
    v_cmp_ne_u64 vcc, v[86:87], v[216:217]
    s_or_b64 s[44:45], s[44:45], vcc
    v_cmp_ne_u64 vcc, v[90:91], v[216:217]
    s_or_b64 s[44:45], s[44:45], vcc
    v_cmp_ne_u64 vcc, v[94:95], v[216:217]
    s_or_b64 s[44:45], s[44:45], vcc
    v_cmp_ne_u64 vcc, v[98:99], v[216:217]
    s_or_b64 s[44:45], s[44:45], vcc
    v_cmp_ne_u64 vcc, v[102:103], v[216:217]
    s_or_b64 s[44:45], s[44:45], vcc
    v_cmp_ne_u64 vcc, v[106:107], v[216:217]
    s_or_b64 s[44:45], s[44:45], vcc
    v_cmp_ne_u64 vcc, v[110:111], v[216:217]
    s_or_b64 s[44:45], s[44:45], vcc
    v_cmp_ne_u64 vcc, v[114:115], v[216:217]
    s_or_b64 s[44:45], s[44:45], vcc
    v_cmp_ne_u64 vcc, v[118:119], v[216:217]
    s_or_b64 s[44:45], s[44:45], vcc
    v_cmp_ne_u64 vcc, v[122:123], v[216:217]
    s_or_b64 s[44:45], s[44:45], vcc
    v_cmp_ne_u64 vcc, v[126:127], v[216:217]
    s_or_b64 s[44:45], s[44:45], vcc
    v_cmp_ne_u64 vcc, v[130:131], v[216:217]
    s_or_b64 s[44:45], s[44:45], vcc
    s_cmp_lg_u64 s[44:45], 0
    s_cbranch_scc1 Lsequen_m_spoll
Lsequen_m_spolled:
    s_waitcnt vmcnt(0)
    s_mov_b32 s74, 0
    s_lshr_b32 s75, s24, 1
    s_add_u32 s75, s75, 2
    s_and_b32 s76, s12, 3
    s_lshl_b32 s60, s76, 1
    s_add_u32 s60, s60, s75
    s_lshl_b32 s76, s76, 2
    s_add_u32 s76, s76, s75
    s_lshl_b32 s61, s11, 4
    s_add_u32 s76, s76, s61
    s_mul_i32 s76, s76, 114688
    s_add_u32 s76, s76, 0x1000000
    s_and_b32 s61, s60, 3
    s_mul_i32 s61, s61, 114688
    s_lshr_b32 s60, s60, 2
    s_lshl_b32 s60, s60, 22
    s_add_u32 s60, s60, s61
    s_lshl_b32 s61, s11, 19
    s_add_u32 s60, s60, s61
    s_cmp_lt_u32 s75, s74
    s_cselect_b32 s76, s60, s76
    s_and_b32 s60, s24, 1
    s_mul_i32 s60, s60, 57344
    s_add_u32 s76, s76, s60
    s_mul_i32 s60, s53, 7168
    s_add_u32 s76, s76, s60
    v_lshlrev_b32 v30, 7, v0
    v_min_u32 v30, 7040, v30
    buffer_load_dword v210, v30, s[20:23], s76 offen
    v_cmp_ne_u32 vcc, s55, v66
    v_add_f32 v40, v68, v72
    v_add_f32 v42, v100, v104
    v_add_f32 v41, v69, v73
    v_add_f32 v43, v101, v105
    v_add_f32 v40, v40, v76
    v_add_f32 v42, v42, v108
    v_add_f32 v41, v41, v77
    v_add_f32 v43, v43, v109
    v_add_f32 v40, v40, v80
    v_add_f32 v42, v42, v112
    v_add_f32 v41, v41, v81
    v_add_f32 v43, v43, v113
    v_add_f32 v40, v40, v84
    v_add_f32 v42, v42, v116
    v_add_f32 v41, v41, v85
    v_add_f32 v43, v43, v117
    v_add_f32 v40, v40, v88
    v_add_f32 v42, v42, v120
    v_add_f32 v41, v41, v89
    v_add_f32 v43, v43, v121
    v_add_f32 v40, v40, v92
    v_add_f32 v42, v42, v124
    v_add_f32 v41, v41, v93
    v_add_f32 v43, v43, v125
    v_add_f32 v40, v40, v96
    v_add_f32 v42, v42, v128
    v_add_f32 v41, v41, v97
    v_add_f32 v43, v43, v129
    s_cmp_eq_u64 vcc, 0
    s_cselect_b32 s54, 1, 2
    v_mov_b32 v48, v40
    v_mov_b32 v49, v41
    v_mov_b32 v50, v42
    v_mov_b32 v51, v43
    s_nop 1
    v_permlane32_swap_b32 v40, v48
    v_permlane32_swap_b32 v41, v49
    v_permlane32_swap_b32 v42, v50
    v_permlane32_swap_b32 v43, v51
    s_nop 1
    v_add_f32 v40, v40, v48
    v_add_f32 v41, v41, v49
    v_add_f32 v42, v42, v50
    v_add_f32 v43, v43, v51
    v_mul_f32 v56, 0x3a800000, v40
    v_mul_f32 v60, 0x3a800000, v41
    v_fma_f32 v60, -v56, v56, v60
    v_max_f32 v60, 0, v60
    v_cvt_pk_bf16_f32 v56, v56, v56
    v_and_b32 v56, 0xffff0000, v56
    v_cvt_pk_bf16_f32 v60, v60, v60
    v_and_b32 v60, 0xffff0000, v60
    v_add_f32 v60, 0x3727c5ac, v60
    v_cvt_pk_bf16_f32 v60, v60, v60
    v_and_b32 v60, 0xffff0000, v60
    v_sqrt_f32 v60, v60
    s_nop 0
    v_cvt_pk_bf16_f32 v60, v60, v60
    v_and_b32 v60, 0xffff0000, v60
    v_rcp_f32 v57, v60
    s_nop 0
    s_lshl_b32 s31, s24, 8
    s_add_u32 s31, s31, 151552
    v_lshl_add_u32 v9, v10, 3, s31
    ds_write_b64 v9, v[56:57]
    v_mov_b32 v9, 153600
    v_mov_b32 v62, 0
    v_mov_b32 v63, s54
    ds_write_b64 v9, v[62:63]
    v_and_b32 v9, 15, v0
    v_and_b32 v12, 16, v0
    v_lshl_add_u32 v9, v12, 1, v9
    s_lshl_b32 s31, s24, 8
    s_add_u32 s31, s31, 152576
    v_lshl_add_u32 v9, v9, 2, s31
    ds_write_b32 v9, v42
    ds_write_b32 v9, v43 offset:64
    s_waitcnt lgkmcnt(0)
    s_barrier
    v_lshlrev_b32 v16, 4, v0
    v_add_u32 v17, 55296, v16
    v_bfe_u32 v9, v0, 1, 3
    v_and_b32 v10, 1, v0
    v_lshlrev_b32 v10, 4, v10
    v_lshl_add_u32 v10, v2, 11, v10
    v_xor_b32 v9, v9, v2
    v_xor_b32 v12, 4, v9
    v_lshl_add_u32 v18, v9, 5, v10
    v_lshl_add_u32 v19, v12, 5, v10
    v_add_u32 v19, 7168, v19
    v_lshl_add_u32 v20, v9, 5, v10
    v_add_u32 v20, 14336, v20
    v_lshl_add_u32 v21, v12, 5, v10
    v_add_u32 v21, 21504, v21
    v_bfe_u32 v9, v0, 1, 2
    v_xor_b32 v9, v9, v2
    v_and_b32 v10, 1, v0
    v_lshlrev_b32 v10, 4, v10
    v_lshl_add_u32 v10, v9, 5, v10
    v_lshrrev_b32 v9, 3, v0
    v_lshl_add_u32 v22, v9, 12, v10
    v_add_u32 v23, 31744, v22
    v_add_u32 v24, 63488, v22
    v_add_u32 v25, 95232, v22
    v_mov_b32 v9, 153724
    ds_read_b32 v9, v9
    s_waitcnt lgkmcnt(0)
    v_readfirstlane_b32 s74, v9
    s_cmp_eq_u32 s74, 0
    s_cselect_b32 s74, 2, 0
    s_and_b32 s47, s12, 3
    s_lshl_b32 s60, s47, 1
    s_add_u32 s60, s60, s24
    s_lshl_b32 s47, s47, 2
    s_add_u32 s47, s47, s24
    s_lshl_b32 s61, s11, 4
    s_add_u32 s47, s47, s61
    s_mul_i32 s47, s47, 114688
    s_add_u32 s47, s47, 0x1000000
    s_and_b32 s61, s60, 3
    s_mul_i32 s61, s61, 114688
    s_lshr_b32 s60, s60, 2
    s_lshl_b32 s60, s60, 22
    s_add_u32 s60, s60, s61
    s_lshl_b32 s61, s11, 19
    s_add_u32 s60, s60, s61
    s_cmp_lt_u32 s24, s74
    s_cselect_b32 s47, s60, s47
    s_mul_i32 s48, s15, 1792
    s_lshl_b32 s27, s24, 4
    s_add_u32 s48, s48, s27
    s_lshl_b32 s48, s48, 11
    s_lshl_b32 s27, s53, 8
    s_add_u32 s48, s48, s27
    s_mul_i32 s36, s53, 7
    s_add_u32 s36, s36, 1
    s_lshr_b32 s36, s36, 1
    s_lshl_b32 s27, s24, 12
    s_add_u32 s28, s27, 16384
    s_lshr_b32 s62, s11, 1
    s_mul_i32 s62, s62, 3
    s_lshr_b32 s62, s62, 1
    s_lshl_b32 s62, s62, 2
    s_min_u32 s52, s36, 24
    s_barrier
    s_add_u32 s37, s36, 0
    s_cmp_ge_u32 s37, 28
    s_cselect_b32 s38, 4, 0
    s_sub_u32 s37, s37, s38
    s_lshl_b32 s26, s37, 17
    s_add_u32 s26, s26, s48
    s_add_u32 m0, s28, 0
    s_nop 0
    buffer_load_dwordx4 v18, s[40:43], s26 offen offset:0 lds
    buffer_load_dwordx4 v19, s[40:43], s26 offen offset:1024 lds
    buffer_load_dwordx4 v20, s[40:43], s26 offen offset:2048 lds
    buffer_load_dwordx4 v21, s[40:43], s26 offen offset:3072 lds
    s_add_u32 s37, s36, 1
    s_cmp_ge_u32 s37, 28
    s_cselect_b32 s38, 4, 0
    s_sub_u32 s37, s37, s38
    s_lshl_b32 s26, s37, 17
    s_add_u32 s26, s26, s48
    s_add_u32 m0, s28, 32768
    s_nop 0
    buffer_load_dwordx4 v18, s[40:43], s26 offen offset:0 lds
    buffer_load_dwordx4 v19, s[40:43], s26 offen offset:1024 lds
    buffer_load_dwordx4 v20, s[40:43], s26 offen offset:2048 lds
    buffer_load_dwordx4 v21, s[40:43], s26 offen offset:3072 lds
    s_add_u32 s37, s36, 2
    s_cmp_ge_u32 s37, 28
    s_cselect_b32 s38, 4, 0
    s_sub_u32 s37, s37, s38
    s_lshl_b32 s26, s37, 17
    s_add_u32 s26, s26, s48
    s_add_u32 m0, s28, 65536
    s_nop 0
    buffer_load_dwordx4 v18, s[40:43], s26 offen offset:0 lds
    buffer_load_dwordx4 v19, s[40:43], s26 offen offset:1024 lds
    buffer_load_dwordx4 v20, s[40:43], s26 offen offset:2048 lds
    buffer_load_dwordx4 v21, s[40:43], s26 offen offset:3072 lds
    s_add_u32 s37, s36, 3
    s_cmp_ge_u32 s37, 28
    s_cselect_b32 s38, 4, 0
    s_sub_u32 s37, s37, s38
    s_lshl_b32 s26, s37, 17
    s_add_u32 s26, s26, s48
    s_add_u32 m0, s28, 98304
    s_nop 0
    buffer_load_dwordx4 v18, s[40:43], s26 offen offset:0 lds
    buffer_load_dwordx4 v19, s[40:43], s26 offen offset:1024 lds
    buffer_load_dwordx4 v20, s[40:43], s26 offen offset:2048 lds
    buffer_load_dwordx4 v21, s[40:43], s26 offen offset:3072 lds
    s_lshl_b32 s31, s53, 7
    s_lshl_b32 s32, s24, 5
    s_add_u32 s31, s31, s32
    s_lshl_b32 s31, s31, 12
    s_lshl_b32 s32, s13, 8
    s_add_u32 s31, s31, s32
    s_lshl_b32 s32, s15, 7
    s_add_u32 s31, s31, s32
    s_add_u32 s31, s31, 0x800000
    s_add_u32 m0, s27, 131072
    s_nop 0
    buffer_load_dwordx4 v22, s[20:23], s31 offen offset:0 lds
    buffer_load_dwordx4 v23, s[20:23], s31 offen offset:1024 lds
    buffer_load_dwordx4 v24, s[20:23], s31 offen offset:2048 lds
    buffer_load_dwordx4 v25, s[20:23], s31 offen offset:3072 lds
    s_waitcnt vmcnt(16)
    s_barrier
    s_mov_b32 s39, 0
    s_mov_b64 exec, 0xff
Lsequen_m_hpoll:
    buffer_load_dwordx2 v[64:65], v11, s[20:23], s51 offen sc1
    s_add_u32 s39, s39, 1
    s_cmp_gt_u32 s39, 0x100000
    s_cbranch_scc1 Lsequen_m_hpolled
    s_waitcnt vmcnt(0)
    v_cmp_ne_u64 vcc, v[64:65], v[216:217]
    s_cbranch_vccnz Lsequen_m_hpoll
Lsequen_m_hpolled:
    s_mov_b64 exec, -1
    s_add_u32 s37, s36, 3
    s_cmp_ge_u32 s37, 28
    s_cselect_b32 s38, 4, 0
    s_sub_u32 s37, s37, s38
    s_lshl_b32 s25, s37, 11
    s_add_u32 s25, s25, s47
    s_add_u32 m0, s27, 98304
    s_nop 0
    buffer_load_dwordx4 v16, s[20:23], s25 offen offset:0 lds
    buffer_load_dwordx4 v16, s[20:23], s25 offen offset:1024 lds
    buffer_load_dwordx4 v17, s[20:23], s25 offen offset:2048 lds
    buffer_load_dwordx4 v17, s[20:23], s25 offen offset:3072 lds
    s_mov_b32 s29, 0
    s_mov_b32 s35, 4
    s_barrier
    s_add_u32 s37, s35, s13
    s_and_b32 s37, s37, 3
    s_andn2_b32 s38, s35, 3
    s_or_b32 s37, s37, s38
    s_sub_u32 s37, s37, 4
    s_add_u32 s37, s37, s62
    s_cmp_ge_u32 s37, 24
    s_cselect_b32 s38, 24, 0
    s_sub_u32 s37, s37, s38
    s_cmp_ge_u32 s37, s52
    s_cselect_b32 s38, 4, 0
    s_add_u32 s37, s37, s38
    s_lshl_b32 s25, s37, 11
    s_add_u32 s25, s25, s47
    s_lshl_b32 s26, s37, 17
    s_add_u32 m0, s27, s29
    s_add_u32 s26, s26, s48
    buffer_load_dwordx4 v16, s[20:23], s25 offen offset:0 lds
    buffer_load_dwordx4 v16, s[20:23], s25 offen offset:1024 lds
    buffer_load_dwordx4 v17, s[20:23], s25 offen offset:2048 lds
    buffer_load_dwordx4 v17, s[20:23], s25 offen offset:3072 lds
    s_add_u32 m0, s28, s29
    s_add_u32 s29, s29, 32768
    buffer_load_dwordx4 v18, s[40:43], s26 offen offset:0 lds
    buffer_load_dwordx4 v19, s[40:43], s26 offen offset:1024 lds
    buffer_load_dwordx4 v20, s[40:43], s26 offen offset:2048 lds
    buffer_load_dwordx4 v21, s[40:43], s26 offen offset:3072 lds
    s_and_b32 s29, s29, 131071
    s_add_u32 s35, s35, 1
    s_waitcnt vmcnt(12)
    s_barrier
    s_add_u32 s37, s35, s13
    s_and_b32 s37, s37, 3
    s_andn2_b32 s38, s35, 3
    s_or_b32 s37, s37, s38
    s_sub_u32 s37, s37, 4
    s_add_u32 s37, s37, s62
    s_cmp_ge_u32 s37, 24
    s_cselect_b32 s38, 24, 0
    s_sub_u32 s37, s37, s38
    s_cmp_ge_u32 s37, s52
    s_cselect_b32 s38, 4, 0
    s_add_u32 s37, s37, s38
    s_lshl_b32 s25, s37, 11
    s_add_u32 s25, s25, s47
    s_lshl_b32 s26, s37, 17
    s_add_u32 m0, s27, s29
    s_add_u32 s26, s26, s48
    buffer_load_dwordx4 v16, s[20:23], s25 offen offset:0 lds
    buffer_load_dwordx4 v16, s[20:23], s25 offen offset:1024 lds
    buffer_load_dwordx4 v17, s[20:23], s25 offen offset:2048 lds
    buffer_load_dwordx4 v17, s[20:23], s25 offen offset:3072 lds
    s_add_u32 m0, s28, s29
    s_add_u32 s29, s29, 32768
    buffer_load_dwordx4 v18, s[40:43], s26 offen offset:0 lds
    buffer_load_dwordx4 v19, s[40:43], s26 offen offset:1024 lds
    buffer_load_dwordx4 v20, s[40:43], s26 offen offset:2048 lds
    buffer_load_dwordx4 v21, s[40:43], s26 offen offset:3072 lds
    s_and_b32 s29, s29, 131071
    s_add_u32 s35, s35, 1
Lsequen_m_l2loop:
    s_waitcnt vmcnt(16)
    s_barrier
    s_add_u32 s37, s35, s13
    s_and_b32 s37, s37, 3
    s_andn2_b32 s38, s35, 3
    s_or_b32 s37, s37, s38
    s_sub_u32 s37, s37, 4
    s_add_u32 s37, s37, s62
    s_cmp_ge_u32 s37, 24
    s_cselect_b32 s38, 24, 0
    s_sub_u32 s37, s37, s38
    s_cmp_ge_u32 s37, s52
    s_cselect_b32 s38, 4, 0
    s_add_u32 s37, s37, s38
    s_lshl_b32 s25, s37, 11
    s_add_u32 s25, s25, s47
    s_lshl_b32 s26, s37, 17
    s_add_u32 m0, s27, s29
    s_add_u32 s26, s26, s48
    buffer_load_dwordx4 v16, s[20:23], s25 offen offset:0 lds
    buffer_load_dwordx4 v16, s[20:23], s25 offen offset:1024 lds
    buffer_load_dwordx4 v17, s[20:23], s25 offen offset:2048 lds
    buffer_load_dwordx4 v17, s[20:23], s25 offen offset:3072 lds
    s_add_u32 m0, s28, s29
    s_add_u32 s29, s29, 32768
    buffer_load_dwordx4 v18, s[40:43], s26 offen offset:0 lds
    buffer_load_dwordx4 v19, s[40:43], s26 offen offset:1024 lds
    buffer_load_dwordx4 v20, s[40:43], s26 offen offset:2048 lds
    buffer_load_dwordx4 v21, s[40:43], s26 offen offset:3072 lds
    s_and_b32 s29, s29, 131071
    s_add_u32 s35, s35, 1
    s_cmp_lt_u32 s35, 28
    s_cbranch_scc1 Lsequen_m_l2loop
    s_waitcnt vmcnt(16)
    s_barrier
    s_waitcnt vmcnt(8)
    s_barrier
    s_waitcnt vmcnt(0)
    s_barrier
    s_waitcnt vmcnt(0)
    s_barrier
    s_endpgm
Lcode_end:
.section .rodata,"a"
.p2align 6
.amdhsa_kernel sequential_preLN__ssm_conv_h3__dense_activation_silu__prompt_kernel
  .amdhsa_next_free_vgpr 224
  .amdhsa_next_free_sgpr 102
  .amdhsa_accum_offset 224
  .amdhsa_group_segment_fixed_size 0
  .amdhsa_kernarg_size 96
  .amdhsa_user_sgpr_count 2
  .amdhsa_user_sgpr_kernarg_segment_ptr 1
  .amdhsa_system_sgpr_workgroup_id_x 1
.end_amdhsa_kernel
```
